```python
import torch

def _softmax(x, axis=-1):
    return torch.softmax(x, dim=axis)
def _gelu(x):
    return torch.nn.functional.gelu(x, approximate="tanh")
def _silu(x):
    return torch.nn.functional.silu(x)
def _sigmoid(x):
    return torch.sigmoid(x)
def _layernorm(x, axis=-1, eps=1e-5):
    m = x.mean(dim=axis, keepdim=True)
    v = x.var(dim=axis, keepdim=True, unbiased=False)
    return (x - m) / torch.sqrt(v + eps)
def _scatter_add(tgt, idx, src, axis=0):
    return tgt.clone().index_add_(axis, idx, src)
def _segment_sum(src, seg, n):
    out = torch.zeros((n,) + src.shape[1:], dtype=src.dtype)
    return out.index_add_(0, seg, src)
def _pad(x, pw):
    flat = tuple(v for pair in reversed(pw) for v in pair)
    return torch.nn.functional.pad(x, flat)

kernel_name = 'gated_mix__mha_block__glu_gated_geglu__prompt'

def setup_inputs():

    _w = (lambda a: (lambda t: t.to(torch.bfloat16) if t.is_floating_point() else t)(torch.as_tensor(a)))
    def _A_setup():
        B, S, D, H = 1, 2048, 640, 32
        return {
            "x": _w((lambda *s: torch.randn(*s, dtype=torch.bfloat16) * 0.05)(B, S, D)),
            "wqkv": _w((lambda *s: torch.randn(*s, dtype=torch.bfloat16) * 0.8)(D, 3 * D)),
            "wo": _w((lambda *s: torch.randn(*s, dtype=torch.bfloat16) * 0.05)(D, D)),
        }
    _A_in = _A_setup()

    def _B_setup():
        B, S, Dm, Df = 1, 2048, 640, 1536
        return {
            "x": _w((lambda *s: torch.randn(*s, dtype=torch.bfloat16) * 0.05)(B, S, Dm)),
            "w_gate": _w((lambda *s: torch.randn(*s, dtype=torch.bfloat16) * 3.2)(Dm, Df) * (Dm ** -0.5)),
            "w_up": _w((lambda *s: torch.randn(*s, dtype=torch.bfloat16) * 3.2)(Dm, Df) * (Dm ** -0.5)),
            "w_down": _w((lambda *s: torch.randn(*s, dtype=torch.bfloat16) * 3.2)(Df, Dm) * (Df ** -0.5)),
        }
    _B_in = _B_setup()

    return {
        "A_x": _A_in["x"],
        "A_wqkv": _A_in["wqkv"],
        "A_wo": _A_in["wo"],
        "B_x": _B_in["x"],
        "B_w_gate": _B_in["w_gate"],
        "B_w_up": _B_in["w_up"],
        "B_w_down": _B_in["w_down"],
        "gate_w": _w((lambda *s: torch.randn(*s, dtype=torch.bfloat16) * 0.05)(640) * 16.0),
    }

def reference(A_x, A_wqkv, A_wo, B_x, B_w_gate, B_w_up, B_w_down, gate_w):
    def _A_ref(x, wqkv, wo):
        B, S, D = x.shape
        H = 32
        Dh = D // H
        qkv = (lambda x, *d: x.permute(*d))((x @ wqkv).reshape(B, S, 3, H, Dh), 2, 0, 3, 1, 4)
        q, k, v = qkv[0], qkv[1], qkv[2]
        scores = torch.einsum("bhqd,bhkd->bhqk", q, k) * (Dh ** -0.5)
        p = _softmax(scores, axis=-1)
        o = torch.einsum("bhqk,bhkd->bhqd", p, v)
        return (lambda x, *d: x.permute(*d))(o, 0, 2, 1, 3).reshape(B, S, D) @ wo

    def _B_ref(x, w_gate, w_up, w_down):
        g = torch.einsum("bsd,df->bsf", x, w_gate)
        u = torch.einsum("bsd,df->bsf", x, w_up)
        h = _gelu(g) * u
        return torch.einsum("bsf,fd->bsd", h, w_down)

    x = A_x
    g = _sigmoid((x * gate_w).sum(-1, keepdims=True))
    a = _A_ref(x, A_wqkv, A_wo)
    b = _B_ref(x, B_w_gate, B_w_up, B_w_down)
    return g * a + (1 - g) * b
```

```asm
; @launch grid=(256,1,1) block=(512,1,1) lds=163840
.amdgcn_target "amdgcn-amd-amdhsa--gfx950"
.text
.globl gated_mix__mha_block__glu_gated_geglu__prompt_kernel
    .p2align 8
    .type gated_mix__mha_block__glu_gated_geglu__prompt_kernel,@function
gated_mix__mha_block__glu_gated_geglu__prompt_kernel:
    s_cmp_ge_u32 s2, 256
    s_cbranch_scc0 L_go
    s_endpgm
L_go:
    s_load_dwordx16 s[36:51], s[0:1], 0
    s_load_dwordx2 s[52:53], s[0:1], 64
    s_load_dwordx2 s[34:35], s[0:1], 72
    s_load_dwordx2 s[54:55], s[0:1], 80
    v_lshrrev_b32 v2, 6, v0
    v_and_b32 v1, 63, v0
    s_nop 0
    v_readfirstlane_b32 s3, v2
    s_and_b32 s61, s2, 7
    s_lshr_b32 s62, s2, 3
    s_lshr_b32 s56, s61, 2
    s_lshl_b32 s56, s56, 3
    s_and_b32 s63, s62, 7
    s_add_u32 s56, s56, s63
    s_and_b32 s57, s61, 3
    s_lshl_b32 s57, s57, 2
    s_lshr_b32 s63, s62, 3
    s_add_u32 s57, s57, s63
    s_and_b32 s58, s3, 3
    s_lshr_b32 s59, s3, 2
    v_lshrrev_b32 v16, 3, v1
    s_lshl_b32 s61, s3, 3
    v_add_u32 v16, s61, v16
    v_lshrrev_b32 v17, 1, v16
    v_and_b32 v17, 7, v17
    v_and_b32 v18, 7, v1
    v_xor_b32 v17, v17, v18
    v_lshlrev_b32 v17, 4, v17
    v_mul_u32_u24 v16, 1280, v16
    v_add_u32 v4, v16, v17
    v_lshrrev_b32 v16, 4, v1
    v_lshlrev_b32 v17, 2, v16
    v_and_b32 v18, 15, v1
    v_xor_b32 v17, v17, v18
    v_lshlrev_b32 v17, 4, v17
    s_lshl_b32 s61, s3, 2
    v_add_u32 v16, s61, v16
    v_mul_u32_u24 v16, 3840, v16
    v_add_u32 v5, v16, v17
    s_mul_i32 s32, s56, 163840
    s_mul_i32 s61, s57, 240
    s_sub_u32 s62, s57, 11
    s_lshl_b32 s62, s62, 8
    s_add_u32 s62, s62, 2560
    s_cmp_lt_u32 s57, 11
    s_cselect_b32 s66, s61, s62
    s_lshl_b32 s74, s3, 10
    s_add_u32 s65, s74, 49152
    v_lshlrev_b32 v2, 2, v1
    s_waitcnt lgkmcnt(0)
    s_mov_b32 s4, s36
    s_mov_b32 s5, s37
    s_and_b32 s5, s5, 0xffff
    s_mov_b32 s6, 2621440
    s_mov_b32 s7, 0x20000
    s_mov_b32 s8, s38
    s_mov_b32 s9, s39
    s_and_b32 s9, s9, 0xffff
    s_mov_b32 s10, 2457600
    s_mov_b32 s11, 0x20000
    s_mov_b32 s28, s34
    s_mov_b32 s29, s35
    s_and_b32 s29, s29, 0xffff
    s_mov_b32 s30, 256
    s_mov_b32 s31, 0x20000
    s_or_b32 s61, s2, s3
    s_cmp_eq_u32 s61, 0
    s_cbranch_scc1 L_rare_k_1
L_back_k_2:
    s_add_u32 m0, s74, 0
    s_add_u32 s33, s32, 0
    buffer_load_dwordx4 v4, s[4:7], s33 offen lds
    s_add_u32 m0, s74, 8192
    s_add_u32 s33, s32, 81920
    buffer_load_dwordx4 v4, s[4:7], s33 offen lds
    s_add_u32 m0, s65, 0
    s_add_u32 s67, s66, 0
    buffer_load_dwordx4 v5, s[8:11], s67 offen lds
    s_add_u32 m0, s65, 8192
    s_add_u32 s67, s66, 122880
    buffer_load_dwordx4 v5, s[8:11], s67 offen lds
    s_mov_b32 s68, s50
    s_mov_b32 s69, s51
    s_and_b32 s69, s69, 0xffff
    s_mov_b32 s70, 1280
    s_mov_b32 s71, 0x20000
    s_lshl_b32 s33, s56, 7
    s_lshl_b32 s61, s57, 3
    s_add_u32 s33, s33, s61
    s_add_u32 s33, s33, s3
    s_lshl_b32 s0, s33, 2
    s_add_u32 s0, s0, 16777216
    s_mov_b32 s12, s44
    s_mov_b32 s13, s45
    s_and_b32 s13, s13, 0xffff
    s_mov_b32 s14, 1966080
    s_mov_b32 s15, 0x20000
    s_mov_b32 s16, s46
    s_mov_b32 s17, s47
    s_and_b32 s17, s17, 0xffff
    s_mov_b32 s18, 1966080
    s_mov_b32 s19, 0x20000
    s_mov_b32 s24, s54
    s_mov_b32 s25, s55
    s_and_b32 s25, s25, 0xffff
    s_mov_b32 s26, 16926720
    s_mov_b32 s27, 0x20000
    s_cmp_lt_u32 s3, 4
    s_cselect_b32 s20, s12, s16
    s_cselect_b32 s21, s13, s17
    s_cselect_b32 s22, s14, s18
    s_cselect_b32 s23, s15, s19
    s_mul_i32 s75, s33, 1280
    s_add_u32 m0, s74, 16384
    s_add_u32 s33, s32, 128
    buffer_load_dwordx4 v4, s[4:7], s33 offen lds
    s_add_u32 m0, s74, 24576
    s_add_u32 s33, s32, 82048
    buffer_load_dwordx4 v4, s[4:7], s33 offen lds
    s_add_u32 m0, s65, 24640
    s_add_u32 s67, s66, 245760
    buffer_load_dwordx4 v5, s[8:11], s67 offen lds
    s_add_u32 m0, s65, 32832
    s_add_u32 s67, s66, 368640
    buffer_load_dwordx4 v5, s[8:11], s67 offen lds
    s_add_u32 m0, s74, 32768
    s_add_u32 s33, s32, 256
    buffer_load_dwordx4 v4, s[4:7], s33 offen lds
    s_add_u32 m0, s74, 40960
    s_add_u32 s33, s32, 82176
    buffer_load_dwordx4 v4, s[4:7], s33 offen lds
    s_add_u32 m0, s65, 49280
    s_add_u32 s67, s66, 491520
    buffer_load_dwordx4 v5, s[8:11], s67 offen lds
    s_add_u32 m0, s65, 57472
    s_add_u32 s67, s66, 614400
    buffer_load_dwordx4 v5, s[8:11], s67 offen lds
    buffer_load_dword v100, v2, s[4:7], s75 offen offset:0
    buffer_load_dword v101, v2, s[4:7], s75 offen offset:256
    buffer_load_dword v102, v2, s[4:7], s75 offen offset:512
    buffer_load_dword v103, v2, s[4:7], s75 offen offset:768
    buffer_load_dword v104, v2, s[4:7], s75 offen offset:1024
    buffer_load_dword v106, v2, s[68:71], 0 offen offset:0
    buffer_load_dword v107, v2, s[68:71], 0 offen offset:256
    buffer_load_dword v108, v2, s[68:71], 0 offen offset:512
    buffer_load_dword v109, v2, s[68:71], 0 offen offset:768
    buffer_load_dword v110, v2, s[68:71], 0 offen offset:1024
    s_mov_b32 s60, s4
    s_mov_b32 s61, s5
    s_mov_b32 s62, 2621440
    s_mov_b32 s64, 10240
    s_cmp_ge_u32 s3, 2
    s_cselect_b32 s60, s8, s60
    s_cselect_b32 s61, s9, s61
    s_cselect_b32 s62, 2457600, s62
    s_cselect_b32 s64, 9600, s64
    s_cmp_ge_u32 s3, 4
    s_cselect_b32 s60, s12, s60
    s_cselect_b32 s61, s13, s61
    s_cselect_b32 s62, 1966080, s62
    s_cselect_b32 s64, 7680, s64
    s_cmp_ge_u32 s3, 5
    s_cselect_b32 s60, s16, s60
    s_cselect_b32 s61, s17, s61
    s_cselect_b32 s62, 1966080, s62
    s_cselect_b32 s64, 7680, s64
    s_cmp_ge_u32 s3, 6
    s_cselect_b32 s60, s48, s60
    s_cselect_b32 s61, s49, s61
    s_cselect_b32 s62, 1966080, s62
    s_cselect_b32 s64, 7680, s64
    s_cmp_ge_u32 s3, 7
    s_cselect_b32 s60, s40, s60
    s_cselect_b32 s61, s41, s61
    s_cselect_b32 s62, 819200, s62
    s_cselect_b32 s64, 3200, s64
    s_and_b32 s61, s61, 0xffff
    s_mov_b32 s63, 0x20000
    s_cmp_lt_u32 s3, 4
    s_cselect_b32 s75, 1, 0
    s_and_b32 s75, s75, s3
    s_lshl_b32 s75, s75, 13
    v_lshlrev_b32 v3, 7, v1
    v_add_u32 v3, s75, v3
    v_cmp_gt_u32 vcc, s64, v3
    s_mul_i32 s64, s64, s2
    s_cmp_lt_u32 s3, 6
    s_cselect_b32 s75, 0, 0x80000000
    v_or_b32 v3, s75, v3
    s_mov_b64 exec, vcc
    buffer_load_dword v59, v3, s[60:63], s64 offen
    s_mov_b64 exec, -1
    v_and_b32 v16, 31, v1
    v_lshrrev_b32 v17, 5, v1
    v_lshrrev_b32 v18, 1, v16
    v_and_b32 v18, 7, v18
    s_lshl_b32 s61, s58, 5
    v_add_u32 v19, s61, v16
    v_lshlrev_b32 v19, 7, v19
    v_add_u32 v20, 0, v17
    v_xor_b32 v20, v20, v18
    v_lshlrev_b32 v20, 4, v20
    v_add_u32 v8, v19, v20
    v_add_u32 v20, 2, v17
    v_xor_b32 v20, v20, v18
    v_lshlrev_b32 v20, 4, v20
    v_add_u32 v9, v19, v20
    v_add_u32 v20, 4, v17
    v_xor_b32 v20, v20, v18
    v_lshlrev_b32 v20, 4, v20
    v_add_u32 v10, v19, v20
    v_add_u32 v20, 6, v17
    v_xor_b32 v20, v20, v18
    v_lshlrev_b32 v20, 4, v20
    v_add_u32 v11, v19, v20
    v_and_b32 v18, 15, v1
    v_lshrrev_b32 v19, 2, v18
    v_lshrrev_b32 v20, 4, v1
    s_cmp_lt_u32 s57, 11
    s_cselect_b32 s61, 8, 0
    s_sub_u32 s61, 128, s61
    s_mul_i32 s61, s61, s59
    v_lshrrev_b32 v21, 1, v20
    v_lshl_add_u32 v21, v21, 3, v19
    v_lshlrev_b32 v27, 8, v21
    v_add_u32 v27, 49152, v27
    v_and_b32 v22, 1, v20
    v_lshlrev_b32 v22, 5, v22
    v_and_b32 v23, 3, v1
    v_lshl_add_u32 v22, v23, 3, v22
    v_add_u32 v22, s61, v22
    v_and_b32 v24, 3, v19
    v_lshlrev_b32 v24, 2, v24
    v_add_u32 v25, 0, v22
    v_lshrrev_b32 v26, 4, v25
    v_xor_b32 v26, v26, v24
    v_lshlrev_b32 v26, 4, v26
    v_and_b32 v25, 15, v25
    v_add3_u32 v12, v27, v26, v25
    v_add_u32 v25, 64, v22
    v_lshrrev_b32 v26, 4, v25
    v_xor_b32 v26, v26, v24
    v_lshlrev_b32 v26, 4, v26
    v_and_b32 v25, 15, v25
    v_add3_u32 v13, v27, v26, v25
    v_mul_u32_u24 v21, 192, v21
    v_and_b32 v22, 1, v20
    v_mul_u32_u24 v22, 12320, v22
    v_lshlrev_b32 v23, 3, v23
    v_add3_u32 v21, v21, v22, v23
    s_mul_i32 s61, s59, 96
    s_add_u32 s61, s61, 49152
    v_add_u32 v15, s61, v21
    s_add_u32 s61, s3, 8
    s_sub_u32 s62, s3, 4
    s_cmp_lt_u32 s3, 4
    s_cselect_b32 s63, s61, s62
    s_cselect_b32 s64, 0, 12320
    s_lshl_b32 s101, s63, 10
    s_add_u32 s101, s101, s64
    s_add_u32 s101, s101, 49152
    s_add_u32 s64, s3, 4
    s_lshl_b32 s71, s64, 10
    s_add_u32 s71, s71, 61472
    s_lshl_b32 s100, s3, 10
    s_add_u32 s100, s100, 49152
    s_lshl_b32 s61, s3, 6
    v_add_u32 v21, s61, v1
    s_mov_b32 s62, 683
    v_mul_lo_u32 v22, v21, s62
    v_lshrrev_b32 v22, 13, v22
    v_mul_u32_u24 v23, 12, v22
    v_sub_u32 v23, v21, v23
    v_lshlrev_b32 v23, 4, v23
    v_mul_u32_u24 v22, 3072, v22
    v_add_u32 v6, v22, v23
    s_lshl_b32 s61, s63, 6
    v_add_u32 v21, s61, v1
    s_mov_b32 s62, 683
    v_mul_lo_u32 v22, v21, s62
    v_lshrrev_b32 v22, 13, v22
    v_mul_u32_u24 v23, 12, v22
    v_sub_u32 v23, v21, v23
    v_lshlrev_b32 v23, 4, v23
    v_mul_u32_u24 v22, 3072, v22
    v_add_u32 v7, v22, v23
    s_lshl_b32 s61, s64, 6
    v_add_u32 v21, s61, v1
    s_mov_b32 s62, 683
    v_mul_lo_u32 v22, v21, s62
    v_lshrrev_b32 v22, 13, v22
    v_mul_u32_u24 v23, 12, v22
    v_sub_u32 v23, v21, v23
    v_lshlrev_b32 v23, 4, v23
    v_mul_u32_u24 v22, 3072, v22
    v_add_u32 v14, v22, v23
    s_mul_i32 s72, s57, 192
    v_lshlrev_b32 v177, 4, v1
    v_and_b32 v16, 31, v1
    v_lshlrev_b32 v178, 3, v16
    v_lshlrev_b32 v176, 2, v16
    s_mul_i32 s61, s59, 2560
    s_add_u32 s61, s61, 143360
    v_add_u32 v179, s61, v177
    v_add_u32 v180, s61, v178
    v_add_u32 v180, 1024, v180
    v_lshrrev_b32 v17, 5, v1
    v_mul_u32_u24 v17, 320, v17
    v_lshlrev_b32 v18, 4, v16
    v_add3_u32 v17, v17, v18, s61
    v_add_u32 v181, 1280, v17
    s_sub_i32 s61, s3, 2
    s_max_i32 s61, s61, 0
    s_min_i32 s61, s61, 4
    s_lshl_b32 s62, s61, 10
    v_add_u32 v192, s62, v177
    v_cmp_le_u32 vcc, 2560, v192
    v_add_u32 v17, 79360, v192
    s_nop 0
    v_cndmask_b32 v192, v192, v17, vcc
    v_lshrrev_b32 v17, 4, v1
    v_lshrrev_b32 v18, 1, v17
    v_lshlrev_b32 v18, 10, v18
    v_and_b32 v19, 1, v17
    v_lshlrev_b32 v19, 9, v19
    v_and_b32 v20, 15, v1
    s_and_b32 s61, s58, 1
    s_lshl_b32 s61, s61, 4
    v_add_u32 v20, s61, v20
    v_lshlrev_b32 v21, 4, v20
    v_add3_u32 v182, v18, v19, v21
    v_mov_b32 v183, v182
    v_lshlrev_b32 v187, 2, v20
    v_lshrrev_b32 v18, 1, v17
    v_lshlrev_b32 v18, 4, v18
    v_and_b32 v19, 1, v17
    v_lshl_add_u32 v18, v19, 2, v18
    v_and_b32 v19, 15, v1
    v_lshrrev_b32 v19, 2, v19
    v_add_u32 v18, v18, v19
    v_mul_u32_u24 v18, 160, v18
    v_and_b32 v19, 3, v1
    v_lshl_add_u32 v18, v19, 3, v18
    s_mul_i32 s61, s59, 5120
    v_add_u32 v184, s61, v18
    v_mov_b32 v193, v184
    v_add_u32 v194, 61440, v184
    s_cmp_ge_u32 s3, 5
    s_cselect_b32 s63, 5, 0
    s_sub_u32 s63, s3, s63
    s_add_u32 s64, s3, 3
    s_min_u32 s64, s64, 4
    s_lshl_b32 s61, s63, 6
    v_add_u32 v22, s61, v1
    s_mov_b32 s62, 205
    v_mul_lo_u32 v23, v22, s62
    v_lshrrev_b32 v23, 11, v23
    v_mul_u32_u24 v24, 10, v23
    v_sub_u32 v24, v22, v24
    v_lshlrev_b32 v24, 4, v24
    v_mul_u32_u24 v25, 1280, v23
    v_add_u32 v185, v25, v24
    v_lshrrev_b32 v25, 4, v23
    v_mul_u32_u24 v25, 20, v25
    v_and_b32 v26, 15, v23
    v_add_u32 v25, v25, v26
    v_mul_u32_u24 v25, 1280, v25
    v_add_u32 v188, v25, v24
    v_lshrrev_b32 v25, 4, v23
    v_lshlrev_b32 v25, 2, v25
    v_bfe_u32 v26, v23, 2, 1
    v_lshl_add_u32 v25, v26, 1, v25
    v_bfe_u32 v26, v23, 3, 1
    v_add_u32 v25, v25, v26
    v_mul_u32_u24 v25, 20, v25
    v_and_b32 v26, 3, v23
    v_add3_u32 v25, v25, v26, 16
    v_mul_u32_u24 v25, 1280, v25
    v_add_u32 v190, v25, v24
    s_lshl_b32 s61, s64, 6
    v_add_u32 v22, s61, v1
    s_mov_b32 s62, 205
    v_mul_lo_u32 v23, v22, s62
    v_lshrrev_b32 v23, 11, v23
    v_mul_u32_u24 v24, 10, v23
    v_sub_u32 v24, v22, v24
    v_lshlrev_b32 v24, 4, v24
    v_mul_u32_u24 v25, 1280, v23
    v_add_u32 v195, v25, v24
    v_lshrrev_b32 v25, 4, v23
    v_mul_u32_u24 v25, 20, v25
    v_and_b32 v26, 15, v23
    v_add_u32 v25, v25, v26
    v_mul_u32_u24 v25, 1280, v25
    v_add_u32 v189, v25, v24
    v_lshrrev_b32 v25, 4, v23
    v_lshlrev_b32 v25, 2, v25
    v_bfe_u32 v26, v23, 2, 1
    v_lshl_add_u32 v25, v26, 1, v25
    v_bfe_u32 v26, v23, 3, 1
    v_add_u32 v25, v25, v26
    v_mul_u32_u24 v25, 20, v25
    v_and_b32 v26, 3, v23
    v_add3_u32 v25, v25, v26, 16
    v_mul_u32_u24 v25, 1280, v25
    v_add_u32 v191, v25, v24
    s_cmp_lt_u32 s3, 2
    s_cselect_b64 vcc, -1, 0
    s_nop 1
    v_cndmask_b32 v186, v192, v195, vcc
    s_waitcnt vmcnt(19)
    s_barrier
    s_cmp_ge_u32 s57, 11
    s_cbranch_scc1 L_vtype
    ds_read_b128 v[16:19], v8 offset:0
    ds_read_b64_tr_b16 v[112:113], v12 offset:0
    ds_read_b64_tr_b16 v[114:115], v12 offset:1024
    ds_read_b64_tr_b16 v[116:117], v13 offset:0
    ds_read_b64_tr_b16 v[118:119], v13 offset:1024
    ds_read_b128 v[20:23], v9 offset:0
    ds_read_b64_tr_b16 v[120:121], v12 offset:4096
    ds_read_b64_tr_b16 v[122:123], v12 offset:5120
    ds_read_b64_tr_b16 v[124:125], v13 offset:4096
    ds_read_b64_tr_b16 v[126:127], v13 offset:5120
    s_waitcnt lgkmcnt(0)
    v_mfma_f32_32x32x16_bf16 v[64:79], v[112:115], v[16:19], 0
    ds_read_b128 v[24:27], v10 offset:0
    ds_read_b64_tr_b16 v[136:137], v12 offset:8192
    ds_read_b64_tr_b16 v[138:139], v12 offset:9216
    ds_read_b64_tr_b16 v[140:141], v13 offset:8192
    v_mfma_f32_32x32x16_bf16 v[80:95], v[116:119], v[16:19], 0
    ds_read_b64_tr_b16 v[142:143], v13 offset:9216
    ds_read_b128 v[28:31], v11 offset:0
    ds_read_b64_tr_b16 v[144:145], v12 offset:12288
    ds_read_b64_tr_b16 v[146:147], v12 offset:13312
    v_mfma_f32_32x32x16_bf16 v[64:79], v[120:123], v[20:23], v[64:79]
    ds_read_b64_tr_b16 v[148:149], v13 offset:12288
    ds_read_b64_tr_b16 v[150:151], v13 offset:13312
    v_mfma_f32_32x32x16_bf16 v[80:95], v[124:127], v[20:23], v[80:95]
    s_waitcnt vmcnt(15) lgkmcnt(0)
    s_barrier
    v_mfma_f32_32x32x16_bf16 v[64:79], v[136:139], v[24:27], v[64:79]
    ds_read_b128 v[48:51], v8 offset:16384
    ds_read_b64_tr_b16 v[112:113], v12 offset:24640
    ds_read_b64_tr_b16 v[114:115], v12 offset:25664
    ds_read_b64_tr_b16 v[116:117], v13 offset:24640
    v_mfma_f32_32x32x16_bf16 v[80:95], v[140:143], v[24:27], v[80:95]
    ds_read_b64_tr_b16 v[118:119], v13 offset:25664
    ds_read_b128 v[52:55], v9 offset:16384
    ds_read_b64_tr_b16 v[120:121], v12 offset:28736
    ds_read_b64_tr_b16 v[122:123], v12 offset:29760
    s_add_u32 m0, s74, 0
    s_add_u32 s33, s32, 384
    buffer_load_dwordx4 v4, s[4:7], s33 offen lds
    v_mfma_f32_32x32x16_bf16 v[64:79], v[144:147], v[28:31], v[64:79]
    ds_read_b64_tr_b16 v[124:125], v13 offset:28736
    ds_read_b64_tr_b16 v[126:127], v13 offset:29760
    v_mfma_f32_32x32x16_bf16 v[80:95], v[148:151], v[28:31], v[80:95]
    s_add_u32 m0, s74, 8192
    s_add_u32 s33, s32, 82304
    buffer_load_dwordx4 v4, s[4:7], s33 offen lds
    s_waitcnt lgkmcnt(0)
    v_mfma_f32_32x32x16_bf16 v[64:79], v[112:115], v[48:51], v[64:79]
    ds_read_b128 v[160:163], v10 offset:16384
    ds_read_b64_tr_b16 v[136:137], v12 offset:32832
    ds_read_b64_tr_b16 v[138:139], v12 offset:33856
    ds_read_b64_tr_b16 v[140:141], v13 offset:32832
    v_mfma_f32_32x32x16_bf16 v[80:95], v[116:119], v[48:51], v[80:95]
    ds_read_b64_tr_b16 v[142:143], v13 offset:33856
    ds_read_b128 v[164:167], v11 offset:16384
    ds_read_b64_tr_b16 v[144:145], v12 offset:36928
    ds_read_b64_tr_b16 v[146:147], v12 offset:37952
    s_add_u32 m0, s65, 0
    s_add_u32 s67, s66, 737280
    buffer_load_dwordx4 v5, s[8:11], s67 offen lds
    v_mfma_f32_32x32x16_bf16 v[64:79], v[120:123], v[52:55], v[64:79]
    ds_read_b64_tr_b16 v[148:149], v13 offset:36928
    ds_read_b64_tr_b16 v[150:151], v13 offset:37952
    v_mfma_f32_32x32x16_bf16 v[80:95], v[124:127], v[52:55], v[80:95]
    s_add_u32 m0, s65, 8192
    s_add_u32 s67, s66, 860160
    buffer_load_dwordx4 v5, s[8:11], s67 offen lds
    s_waitcnt vmcnt(15) lgkmcnt(0)
    s_barrier
    v_mfma_f32_32x32x16_bf16 v[64:79], v[136:139], v[160:163], v[64:79]
    ds_read_b128 v[168:171], v8 offset:32768
    ds_read_b64_tr_b16 v[112:113], v12 offset:49280
    ds_read_b64_tr_b16 v[114:115], v12 offset:50304
    ds_read_b64_tr_b16 v[116:117], v13 offset:49280
    v_mfma_f32_32x32x16_bf16 v[80:95], v[140:143], v[160:163], v[80:95]
    ds_read_b64_tr_b16 v[118:119], v13 offset:50304
    ds_read_b128 v[172:175], v9 offset:32768
    ds_read_b64_tr_b16 v[120:121], v12 offset:53376
    ds_read_b64_tr_b16 v[122:123], v12 offset:54400
    s_add_u32 m0, s74, 16384
    s_add_u32 s33, s32, 512
    buffer_load_dwordx4 v4, s[4:7], s33 offen lds
    v_mfma_f32_32x32x16_bf16 v[64:79], v[144:147], v[164:167], v[64:79]
    ds_read_b64_tr_b16 v[124:125], v13 offset:53376
    ds_read_b64_tr_b16 v[126:127], v13 offset:54400
    v_mfma_f32_32x32x16_bf16 v[80:95], v[148:151], v[164:167], v[80:95]
    s_add_u32 m0, s74, 24576
    s_add_u32 s33, s32, 82432
    buffer_load_dwordx4 v4, s[4:7], s33 offen lds
    s_waitcnt lgkmcnt(0)
    v_mfma_f32_32x32x16_bf16 v[64:79], v[112:115], v[168:171], v[64:79]
    ds_read_b128 v[200:203], v10 offset:32768
    ds_read_b64_tr_b16 v[136:137], v12 offset:57472
    ds_read_b64_tr_b16 v[138:139], v12 offset:58496
    ds_read_b64_tr_b16 v[140:141], v13 offset:57472
    v_mfma_f32_32x32x16_bf16 v[80:95], v[116:119], v[168:171], v[80:95]
    ds_read_b64_tr_b16 v[142:143], v13 offset:58496
    ds_read_b128 v[204:207], v11 offset:32768
    ds_read_b64_tr_b16 v[144:145], v12 offset:61568
    ds_read_b64_tr_b16 v[146:147], v12 offset:62592
    s_add_u32 m0, s65, 24640
    s_add_u32 s67, s66, 983040
    buffer_load_dwordx4 v5, s[8:11], s67 offen lds
    v_mfma_f32_32x32x16_bf16 v[64:79], v[120:123], v[172:175], v[64:79]
    ds_read_b64_tr_b16 v[148:149], v13 offset:61568
    ds_read_b64_tr_b16 v[150:151], v13 offset:62592
    v_mfma_f32_32x32x16_bf16 v[80:95], v[124:127], v[172:175], v[80:95]
    s_add_u32 m0, s65, 32832
    s_add_u32 s67, s66, 1105920
    buffer_load_dwordx4 v5, s[8:11], s67 offen lds
    s_waitcnt vmcnt(4) lgkmcnt(0)
    s_barrier
    v_mfma_f32_32x32x16_bf16 v[64:79], v[136:139], v[200:203], v[64:79]
    ds_read_b128 v[208:211], v8 offset:0
    ds_read_b64_tr_b16 v[112:113], v12 offset:0
    ds_read_b64_tr_b16 v[114:115], v12 offset:1024
    ds_read_b64_tr_b16 v[116:117], v13 offset:0
    v_mfma_f32_32x32x16_bf16 v[80:95], v[140:143], v[200:203], v[80:95]
    ds_read_b64_tr_b16 v[118:119], v13 offset:1024
    ds_read_b128 v[212:215], v9 offset:0
    ds_read_b64_tr_b16 v[120:121], v12 offset:4096
    ds_read_b64_tr_b16 v[122:123], v12 offset:5120
    s_add_u32 m0, s74, 32768
    s_add_u32 s33, s32, 640
    buffer_load_dwordx4 v4, s[4:7], s33 offen lds
    v_mfma_f32_32x32x16_bf16 v[64:79], v[144:147], v[204:207], v[64:79]
    ds_read_b64_tr_b16 v[124:125], v13 offset:4096
    ds_read_b64_tr_b16 v[126:127], v13 offset:5120
    v_mfma_f32_32x32x16_bf16 v[80:95], v[148:151], v[204:207], v[80:95]
    s_add_u32 m0, s74, 40960
    s_add_u32 s33, s32, 82560
    buffer_load_dwordx4 v4, s[4:7], s33 offen lds
    s_waitcnt lgkmcnt(0)
    v_mfma_f32_32x32x16_bf16 v[64:79], v[112:115], v[208:211], v[64:79]
    ds_read_b128 v[216:219], v10 offset:0
    ds_read_b64_tr_b16 v[136:137], v12 offset:8192
    ds_read_b64_tr_b16 v[138:139], v12 offset:9216
    ds_read_b64_tr_b16 v[140:141], v13 offset:8192
    v_mov_b32 v56, 0
    v_dot2_f32_bf16 v56, v100, v106, v56
    v_dot2_f32_bf16 v56, v101, v107, v56
    v_dot2_f32_bf16 v56, v102, v108, v56
    v_dot2_f32_bf16 v56, v103, v109, v56
    v_dot2_f32_bf16 v56, v104, v110, v56
    v_mfma_f32_32x32x16_bf16 v[80:95], v[116:119], v[208:211], v[80:95]
    ds_read_b64_tr_b16 v[142:143], v13 offset:9216
    ds_read_b128 v[220:223], v11 offset:0
    ds_read_b64_tr_b16 v[144:145], v12 offset:12288
    ds_read_b64_tr_b16 v[146:147], v12 offset:13312
    s_add_u32 m0, s65, 49280
    s_add_u32 s67, s66, 1228800
    buffer_load_dwordx4 v5, s[8:11], s67 offen lds
    s_nop 3
    v_add_f32_dpp v56, v56, v56 row_shr:1 row_mask:0xf bank_mask:0xf bound_ctrl:0
    s_nop 1
    v_mfma_f32_32x32x16_bf16 v[64:79], v[120:123], v[212:215], v[64:79]
    ds_read_b64_tr_b16 v[148:149], v13 offset:12288
    ds_read_b64_tr_b16 v[150:151], v13 offset:13312
    v_add_f32_dpp v56, v56, v56 row_shr:2 row_mask:0xf bank_mask:0xf bound_ctrl:0
    s_nop 1
    v_add_f32_dpp v56, v56, v56 row_shr:4 row_mask:0xf bank_mask:0xf bound_ctrl:0
    s_nop 1
    v_add_f32_dpp v56, v56, v56 row_shr:8 row_mask:0xf bank_mask:0xf bound_ctrl:0
    s_nop 1
    v_add_f32_dpp v56, v56, v56 row_bcast:15 row_mask:0xa bank_mask:0xf
    s_nop 1
    v_mfma_f32_32x32x16_bf16 v[80:95], v[124:127], v[212:215], v[80:95]
    s_add_u32 m0, s65, 57472
    s_add_u32 s67, s66, 1351680
    buffer_load_dwordx4 v5, s[8:11], s67 offen lds
    v_add_f32_dpp v56, v56, v56 row_bcast:31 row_mask:0xc bank_mask:0xf
    s_nop 1
    v_mul_f32 v56, 0xbfb8aa3b, v56
    v_exp_f32 v56, v56
    s_nop 0
    v_add_f32 v56, 1.0, v56
    v_rcp_f32 v63, v56
    s_waitcnt vmcnt(4) lgkmcnt(0)
    s_barrier
    v_mfma_f32_32x32x16_bf16 v[64:79], v[136:139], v[216:219], v[64:79]
    ds_read_b128 v[224:227], v8 offset:16384
    ds_read_b64_tr_b16 v[112:113], v12 offset:24640
    ds_read_b64_tr_b16 v[114:115], v12 offset:25664
    ds_read_b64_tr_b16 v[116:117], v13 offset:24640
    v_mfma_f32_32x32x16_bf16 v[80:95], v[140:143], v[216:219], v[80:95]
    ds_read_b64_tr_b16 v[118:119], v13 offset:25664
    ds_read_b128 v[228:231], v9 offset:16384
    ds_read_b64_tr_b16 v[120:121], v12 offset:28736
    ds_read_b64_tr_b16 v[122:123], v12 offset:29760
    s_add_u32 m0, s74, 0
    s_add_u32 s33, s32, 768
    buffer_load_dwordx4 v4, s[4:7], s33 offen lds
    v_mfma_f32_32x32x16_bf16 v[64:79], v[144:147], v[220:223], v[64:79]
    ds_read_b64_tr_b16 v[124:125], v13 offset:28736
    ds_read_b64_tr_b16 v[126:127], v13 offset:29760
    v_mfma_f32_32x32x16_bf16 v[80:95], v[148:151], v[220:223], v[80:95]
    s_add_u32 m0, s74, 8192
    s_add_u32 s33, s32, 82688
    buffer_load_dwordx4 v4, s[4:7], s33 offen lds
    s_waitcnt lgkmcnt(0)
    v_mfma_f32_32x32x16_bf16 v[64:79], v[112:115], v[224:227], v[64:79]
    ds_read_b128 v[232:235], v10 offset:16384
    ds_read_b64_tr_b16 v[136:137], v12 offset:32832
    ds_read_b64_tr_b16 v[138:139], v12 offset:33856
    ds_read_b64_tr_b16 v[140:141], v13 offset:32832
    v_mfma_f32_32x32x16_bf16 v[80:95], v[116:119], v[224:227], v[80:95]
    ds_read_b64_tr_b16 v[142:143], v13 offset:33856
    ds_read_b128 v[236:239], v11 offset:16384
    ds_read_b64_tr_b16 v[144:145], v12 offset:36928
    ds_read_b64_tr_b16 v[146:147], v12 offset:37952
    s_add_u32 m0, s65, 0
    s_add_u32 s67, s66, 1474560
    buffer_load_dwordx4 v5, s[8:11], s67 offen lds
    v_mfma_f32_32x32x16_bf16 v[64:79], v[120:123], v[228:231], v[64:79]
    ds_read_b64_tr_b16 v[148:149], v13 offset:36928
    ds_read_b64_tr_b16 v[150:151], v13 offset:37952
    v_mfma_f32_32x32x16_bf16 v[80:95], v[124:127], v[228:231], v[80:95]
    s_add_u32 m0, s65, 8192
    s_add_u32 s67, s66, 1597440
    buffer_load_dwordx4 v5, s[8:11], s67 offen lds
    s_waitcnt vmcnt(4) lgkmcnt(0)
    s_barrier
    v_mfma_f32_32x32x16_bf16 v[64:79], v[136:139], v[232:235], v[64:79]
    ds_read_b128 v[240:243], v8 offset:32768
    ds_read_b64_tr_b16 v[112:113], v12 offset:49280
    ds_read_b64_tr_b16 v[114:115], v12 offset:50304
    ds_read_b64_tr_b16 v[116:117], v13 offset:49280
    v_mfma_f32_32x32x16_bf16 v[80:95], v[140:143], v[232:235], v[80:95]
    ds_read_b64_tr_b16 v[118:119], v13 offset:50304
    ds_read_b128 v[244:247], v9 offset:32768
    ds_read_b64_tr_b16 v[120:121], v12 offset:53376
    ds_read_b64_tr_b16 v[122:123], v12 offset:54400
    s_add_u32 m0, s74, 16384
    s_add_u32 s33, s32, 896
    buffer_load_dwordx4 v4, s[4:7], s33 offen lds
    v_mfma_f32_32x32x16_bf16 v[64:79], v[144:147], v[236:239], v[64:79]
    ds_read_b64_tr_b16 v[124:125], v13 offset:53376
    ds_read_b64_tr_b16 v[126:127], v13 offset:54400
    v_mfma_f32_32x32x16_bf16 v[80:95], v[148:151], v[236:239], v[80:95]
    s_add_u32 m0, s74, 24576
    s_add_u32 s33, s32, 82816
    buffer_load_dwordx4 v4, s[4:7], s33 offen lds
    s_waitcnt lgkmcnt(0)
    v_mfma_f32_32x32x16_bf16 v[64:79], v[112:115], v[240:243], v[64:79]
    ds_read_b128 v[248:251], v10 offset:32768
    ds_read_b64_tr_b16 v[136:137], v12 offset:57472
    ds_read_b64_tr_b16 v[138:139], v12 offset:58496
    ds_read_b64_tr_b16 v[140:141], v13 offset:57472
    v_mfma_f32_32x32x16_bf16 v[80:95], v[116:119], v[240:243], v[80:95]
    ds_read_b64_tr_b16 v[142:143], v13 offset:58496
    ds_read_b128 v[252:255], v11 offset:32768
    ds_read_b64_tr_b16 v[144:145], v12 offset:61568
    ds_read_b64_tr_b16 v[146:147], v12 offset:62592
    s_add_u32 m0, s65, 24640
    s_add_u32 s67, s66, 1720320
    buffer_load_dwordx4 v5, s[8:11], s67 offen lds
    v_mfma_f32_32x32x16_bf16 v[64:79], v[120:123], v[244:247], v[64:79]
    ds_read_b64_tr_b16 v[148:149], v13 offset:61568
    ds_read_b64_tr_b16 v[150:151], v13 offset:62592
    v_mfma_f32_32x32x16_bf16 v[80:95], v[124:127], v[244:247], v[80:95]
    s_add_u32 m0, s65, 32832
    s_add_u32 s67, s66, 1843200
    buffer_load_dwordx4 v5, s[8:11], s67 offen lds
    s_waitcnt vmcnt(4) lgkmcnt(0)
    s_barrier
    v_mfma_f32_32x32x16_bf16 v[64:79], v[136:139], v[248:251], v[64:79]
    ds_read_b128 v[32:35], v8 offset:0
    ds_read_b64_tr_b16 v[112:113], v12 offset:0
    ds_read_b64_tr_b16 v[114:115], v12 offset:1024
    ds_read_b64_tr_b16 v[116:117], v13 offset:0
    v_mfma_f32_32x32x16_bf16 v[80:95], v[140:143], v[248:251], v[80:95]
    ds_read_b64_tr_b16 v[118:119], v13 offset:1024
    ds_read_b128 v[36:39], v9 offset:0
    ds_read_b64_tr_b16 v[120:121], v12 offset:4096
    ds_read_b64_tr_b16 v[122:123], v12 offset:5120
    s_add_u32 m0, s74, 32768
    s_add_u32 s33, s32, 1024
    buffer_load_dwordx4 v4, s[4:7], s33 offen lds
    v_mfma_f32_32x32x16_bf16 v[64:79], v[144:147], v[252:255], v[64:79]
    ds_read_b64_tr_b16 v[124:125], v13 offset:4096
    ds_read_b64_tr_b16 v[126:127], v13 offset:5120
    v_mfma_f32_32x32x16_bf16 v[80:95], v[148:151], v[252:255], v[80:95]
    s_add_u32 m0, s74, 40960
    s_add_u32 s33, s32, 82944
    buffer_load_dwordx4 v4, s[4:7], s33 offen lds
    s_waitcnt lgkmcnt(0)
    v_mfma_f32_32x32x16_bf16 v[64:79], v[112:115], v[32:35], v[64:79]
    ds_read_b128 v[40:43], v10 offset:0
    ds_read_b64_tr_b16 v[136:137], v12 offset:8192
    ds_read_b64_tr_b16 v[138:139], v12 offset:9216
    ds_read_b64_tr_b16 v[140:141], v13 offset:8192
    v_mfma_f32_32x32x16_bf16 v[80:95], v[116:119], v[32:35], v[80:95]
    ds_read_b64_tr_b16 v[142:143], v13 offset:9216
    ds_read_b128 v[44:47], v11 offset:0
    ds_read_b64_tr_b16 v[144:145], v12 offset:12288
    ds_read_b64_tr_b16 v[146:147], v12 offset:13312
    s_add_u32 m0, s65, 49280
    s_add_u32 s67, s66, 1966080
    buffer_load_dwordx4 v5, s[8:11], s67 offen lds
    v_mfma_f32_32x32x16_bf16 v[64:79], v[120:123], v[36:39], v[64:79]
    ds_read_b64_tr_b16 v[148:149], v13 offset:12288
    ds_read_b64_tr_b16 v[150:151], v13 offset:13312
    v_mfma_f32_32x32x16_bf16 v[80:95], v[124:127], v[36:39], v[80:95]
    s_add_u32 m0, s65, 57472
    s_add_u32 s67, s66, 2088960
    buffer_load_dwordx4 v5, s[8:11], s67 offen lds
    s_waitcnt vmcnt(4) lgkmcnt(0)
    s_barrier
    v_mfma_f32_32x32x16_bf16 v[64:79], v[136:139], v[40:43], v[64:79]
    ds_read_b128 v[32:35], v8 offset:16384
    ds_read_b64_tr_b16 v[112:113], v12 offset:24640
    ds_read_b64_tr_b16 v[114:115], v12 offset:25664
    ds_read_b64_tr_b16 v[116:117], v13 offset:24640
    v_mfma_f32_32x32x16_bf16 v[80:95], v[140:143], v[40:43], v[80:95]
    ds_read_b64_tr_b16 v[118:119], v13 offset:25664
    ds_read_b128 v[36:39], v9 offset:16384
    ds_read_b64_tr_b16 v[120:121], v12 offset:28736
    ds_read_b64_tr_b16 v[122:123], v12 offset:29760
    s_add_u32 m0, s74, 0
    s_add_u32 s33, s32, 1152
    buffer_load_dwordx4 v4, s[4:7], s33 offen lds
    v_mfma_f32_32x32x16_bf16 v[64:79], v[144:147], v[44:47], v[64:79]
    ds_read_b64_tr_b16 v[124:125], v13 offset:28736
    ds_read_b64_tr_b16 v[126:127], v13 offset:29760
    v_mfma_f32_32x32x16_bf16 v[80:95], v[148:151], v[44:47], v[80:95]
    s_add_u32 m0, s74, 8192
    s_add_u32 s33, s32, 83072
    buffer_load_dwordx4 v4, s[4:7], s33 offen lds
    s_waitcnt lgkmcnt(0)
    v_mfma_f32_32x32x16_bf16 v[64:79], v[112:115], v[32:35], v[64:79]
    ds_read_b128 v[40:43], v10 offset:16384
    ds_read_b64_tr_b16 v[136:137], v12 offset:32832
    ds_read_b64_tr_b16 v[138:139], v12 offset:33856
    ds_read_b64_tr_b16 v[140:141], v13 offset:32832
    v_mfma_f32_32x32x16_bf16 v[80:95], v[116:119], v[32:35], v[80:95]
    ds_read_b64_tr_b16 v[142:143], v13 offset:33856
    ds_read_b128 v[44:47], v11 offset:16384
    ds_read_b64_tr_b16 v[144:145], v12 offset:36928
    ds_read_b64_tr_b16 v[146:147], v12 offset:37952
    s_add_u32 m0, s65, 0
    s_add_u32 s67, s66, 2211840
    buffer_load_dwordx4 v5, s[8:11], s67 offen lds
    v_mfma_f32_32x32x16_bf16 v[64:79], v[120:123], v[36:39], v[64:79]
    ds_read_b64_tr_b16 v[148:149], v13 offset:36928
    ds_read_b64_tr_b16 v[150:151], v13 offset:37952
    v_mfma_f32_32x32x16_bf16 v[80:95], v[124:127], v[36:39], v[80:95]
    s_add_u32 m0, s65, 8192
    s_add_u32 s67, s66, 2334720
    buffer_load_dwordx4 v5, s[8:11], s67 offen lds
    s_waitcnt vmcnt(4) lgkmcnt(0)
    s_barrier
    v_mfma_f32_32x32x16_bf16 v[64:79], v[136:139], v[40:43], v[64:79]
    ds_read_b128 v[32:35], v8 offset:32768
    ds_read_b64_tr_b16 v[112:113], v12 offset:49280
    ds_read_b64_tr_b16 v[114:115], v12 offset:50304
    ds_read_b64_tr_b16 v[116:117], v13 offset:49280
    v_mfma_f32_32x32x16_bf16 v[80:95], v[140:143], v[40:43], v[80:95]
    ds_read_b64_tr_b16 v[118:119], v13 offset:50304
    ds_read_b128 v[36:39], v9 offset:32768
    ds_read_b64_tr_b16 v[120:121], v12 offset:53376
    ds_read_b64_tr_b16 v[122:123], v12 offset:54400
    s_add_u32 m0, s100, 24640
    s_add_u32 s67, s72, 0
    buffer_load_dwordx4 v6, s[12:15], s67 offen lds
    v_mfma_f32_32x32x16_bf16 v[64:79], v[144:147], v[44:47], v[64:79]
    ds_read_b64_tr_b16 v[124:125], v13 offset:53376
    ds_read_b64_tr_b16 v[126:127], v13 offset:54400
    v_mfma_f32_32x32x16_bf16 v[80:95], v[148:151], v[44:47], v[80:95]
    s_add_u32 m0, s101, 24640
    s_add_u32 s67, s72, 0
    buffer_load_dwordx4 v7, s[20:23], s67 offen lds
    s_waitcnt lgkmcnt(0)
    v_mfma_f32_32x32x16_bf16 v[64:79], v[112:115], v[32:35], v[64:79]
    ds_read_b128 v[40:43], v10 offset:32768
    ds_read_b64_tr_b16 v[136:137], v12 offset:57472
    ds_read_b64_tr_b16 v[138:139], v12 offset:58496
    ds_read_b64_tr_b16 v[140:141], v13 offset:57472
    s_mul_i32 s69, s57, 6
    s_mul_i32 s61, s59, 3
    s_add_u32 s69, s69, s61
    s_lshl_b32 s70, s56, 2
    s_add_u32 s70, s70, s58
    s_add_u32 s61, s69, 1
    s_cmp_lt_u32 s61, 32
    s_cselect_b32 s47, 0x3ea52b5c, 1.0
    s_add_u32 s61, s69, 2
    s_cmp_lt_u32 s61, 32
    s_cselect_b32 s73, 0x3ea52b5c, 1.0
    v_mfma_f32_32x32x16_bf16 v[80:95], v[116:119], v[32:35], v[80:95]
    ds_read_b64_tr_b16 v[142:143], v13 offset:58496
    ds_read_b128 v[44:47], v11 offset:32768
    ds_read_b64_tr_b16 v[144:145], v12 offset:61568
    ds_read_b64_tr_b16 v[146:147], v12 offset:62592
    s_add_u32 m0, s71, 24640
    s_add_u32 s67, s72, 0
    buffer_load_dwordx4 v14, s[16:19], s67 offen lds
    s_add_u32 s61, s69, 0
    s_lshl_b32 s62, s61, 6
    s_add_u32 s62, s62, s70
    s_mul_i32 s63, s62, 1280
    s_sub_u32 s62, s62, 2048
    s_mul_i32 s62, s62, 2560
    s_add_u32 s62, s62, 2621440
    s_cmp_lt_u32 s61, 32
    s_cselect_b32 s44, s63, s62
    v_mfma_f32_32x32x16_bf16 v[64:79], v[120:123], v[36:39], v[64:79]
    ds_read_b64_tr_b16 v[148:149], v13 offset:61568
    ds_read_b64_tr_b16 v[150:151], v13 offset:62592
    s_add_u32 s61, s69, 1
    s_lshl_b32 s62, s61, 6
    s_add_u32 s62, s62, s70
    s_mul_i32 s63, s62, 1280
    s_sub_u32 s62, s62, 2048
    s_mul_i32 s62, s62, 2560
    s_add_u32 s62, s62, 2621440
    s_cmp_lt_u32 s61, 32
    s_cselect_b32 s45, s63, s62
    s_add_u32 s61, s69, 2
    s_lshl_b32 s62, s61, 6
    s_add_u32 s62, s62, s70
    s_mul_i32 s63, s62, 1280
    v_mfma_f32_32x32x16_bf16 v[80:95], v[124:127], v[36:39], v[80:95]
    s_sub_u32 s62, s62, 2048
    s_mul_i32 s62, s62, 2560
    s_add_u32 s62, s62, 2621440
    s_cmp_lt_u32 s61, 32
    s_cselect_b32 s46, s63, s62
    v_xor_b32 v58, 512, v177
    s_cmp_ge_u32 s69, 63
    s_cselect_b32 s61, 0x80000000, 0
    v_or_b32 v58, s61, v58
    v_or_b32 v59, s61, v177
    v_or_b32 v60, s61, v178
    s_waitcnt vmcnt(3) lgkmcnt(0)
    s_barrier
    v_mfma_f32_32x32x16_bf16 v[64:79], v[136:139], v[40:43], v[64:79]
    ds_read_b128 v[32:35], v8 offset:0
    ds_read_b64_tr_b16 v[112:113], v12 offset:0
    ds_read_b64_tr_b16 v[114:115], v12 offset:1024
    ds_read_b64_tr_b16 v[116:117], v13 offset:0
    v_mfma_f32_32x32x16_bf16 v[80:95], v[140:143], v[40:43], v[80:95]
    ds_read_b64_tr_b16 v[118:119], v13 offset:1024
    ds_read_b128 v[36:39], v9 offset:0
    ds_read_b64_tr_b16 v[120:121], v12 offset:4096
    ds_read_b64_tr_b16 v[122:123], v12 offset:5120
    s_add_u32 m0, s100, 49280
    s_add_u32 s67, s72, 196608
    buffer_load_dwordx4 v6, s[12:15], s67 offen lds
    v_mfma_f32_32x32x16_bf16 v[64:79], v[144:147], v[44:47], v[64:79]
    ds_read_b64_tr_b16 v[124:125], v13 offset:4096
    ds_read_b64_tr_b16 v[126:127], v13 offset:5120
    v_mfma_f32_32x32x16_bf16 v[80:95], v[148:151], v[44:47], v[80:95]
    s_add_u32 m0, s101, 49280
    s_add_u32 s67, s72, 196608
    buffer_load_dwordx4 v7, s[20:23], s67 offen lds
    s_waitcnt lgkmcnt(0)
    v_mfma_f32_32x32x16_bf16 v[64:79], v[112:115], v[32:35], v[64:79]
    ds_read_b128 v[40:43], v10 offset:0
    ds_read_b64_tr_b16 v[136:137], v12 offset:8192
    ds_read_b64_tr_b16 v[138:139], v12 offset:9216
    ds_read_b64_tr_b16 v[140:141], v13 offset:8192
    v_mfma_f32_32x32x16_bf16 v[80:95], v[116:119], v[32:35], v[80:95]
    ds_read_b64_tr_b16 v[142:143], v13 offset:9216
    ds_read_b128 v[44:47], v11 offset:0
    ds_read_b64_tr_b16 v[144:145], v12 offset:12288
    ds_read_b64_tr_b16 v[146:147], v12 offset:13312
    s_add_u32 m0, s71, 49280
    s_add_u32 s67, s72, 196608
    buffer_load_dwordx4 v14, s[16:19], s67 offen lds
    v_mfma_f32_32x32x16_bf16 v[64:79], v[120:123], v[36:39], v[64:79]
    ds_read_b64_tr_b16 v[148:149], v13 offset:12288
    ds_read_b64_tr_b16 v[150:151], v13 offset:13312
    v_mfma_f32_32x32x16_bf16 v[80:95], v[124:127], v[36:39], v[80:95]
    s_waitcnt vmcnt(3) lgkmcnt(0)
    s_barrier
    v_mfma_f32_32x32x16_bf16 v[64:79], v[136:139], v[40:43], v[64:79]
    s_add_u32 m0, s100, 0
    s_add_u32 s67, s72, 393216
    buffer_load_dwordx4 v6, s[12:15], s67 offen lds
    v_mfma_f32_32x32x16_bf16 v[80:95], v[140:143], v[40:43], v[80:95]
    s_add_u32 m0, s101, 0
    s_add_u32 s67, s72, 393216
    buffer_load_dwordx4 v7, s[20:23], s67 offen lds
    v_mfma_f32_32x32x16_bf16 v[64:79], v[144:147], v[44:47], v[64:79]
    s_add_u32 m0, s71, 0
    s_add_u32 s67, s72, 393216
    buffer_load_dwordx4 v14, s[16:19], s67 offen lds
    v_mfma_f32_32x32x16_bf16 v[80:95], v[148:151], v[44:47], v[80:95]
    s_waitcnt lgkmcnt(0)
    s_nop 7
    s_nop 7
    v_mul_f32 v64, s47, v64
    v_mul_f32 v65, s47, v65
    v_mul_f32 v66, s47, v66
    v_mul_f32 v67, s47, v67
    v_mul_f32 v68, s47, v68
    v_mul_f32 v69, s47, v69
    v_mul_f32 v70, s47, v70
    v_mul_f32 v71, s47, v71
    v_mul_f32 v72, s47, v72
    v_mul_f32 v73, s47, v73
    v_mul_f32 v74, s47, v74
    v_mul_f32 v75, s47, v75
    v_mul_f32 v76, s47, v76
    v_mul_f32 v77, s47, v77
    v_mul_f32 v78, s47, v78
    v_mul_f32 v79, s47, v79
    v_mul_f32 v80, s47, v80
    v_mul_f32 v81, s47, v81
    v_mul_f32 v82, s47, v82
    v_mul_f32 v83, s47, v83
    v_mul_f32 v84, s73, v84
    v_mul_f32 v85, s73, v85
    v_mul_f32 v86, s73, v86
    v_mul_f32 v87, s73, v87
    v_mul_f32 v88, s73, v88
    v_mul_f32 v89, s73, v89
    v_mul_f32 v90, s73, v90
    v_mul_f32 v91, s73, v91
    v_mul_f32 v92, s73, v92
    v_mul_f32 v93, s73, v93
    v_mul_f32 v94, s73, v94
    v_mul_f32 v95, s73, v95
    v_cvt_pk_bf16_f32 v32, v64, v65
    v_cvt_pk_bf16_f32 v33, v66, v67
    v_cvt_pk_bf16_f32 v34, v68, v69
    v_cvt_pk_bf16_f32 v35, v70, v71
    v_cvt_pk_bf16_f32 v36, v72, v73
    v_cvt_pk_bf16_f32 v37, v74, v75
    v_cvt_pk_bf16_f32 v38, v76, v77
    v_cvt_pk_bf16_f32 v39, v78, v79
    v_cvt_pk_bf16_f32 v40, v80, v81
    v_cvt_pk_bf16_f32 v41, v82, v83
    v_cvt_pk_bf16_f32 v42, v84, v85
    v_cvt_pk_bf16_f32 v43, v86, v87
    v_cvt_pk_bf16_f32 v44, v88, v89
    v_cvt_pk_bf16_f32 v45, v90, v91
    v_cvt_pk_bf16_f32 v46, v92, v93
    v_cvt_pk_bf16_f32 v47, v94, v95
    s_mov_b32 s35, 0
    v_mov_b32 v3, 0
    s_mov_b32 exec_lo, 0
    s_mov_b32 exec_hi, 0x80000000
    buffer_store_dword v63, v3, s[24:27], s0 offen sc1
    s_mov_b64 exec, -1
    buffer_load_dword v62, v3, s[28:31], 0 offen sc1
    ds_read_b64_tr_b16 v[112:113], v15 offset:24640
    ds_read_b64_tr_b16 v[114:115], v15 offset:25408
    ds_read_b64_tr_b16 v[116:117], v15 offset:24672
    ds_read_b64_tr_b16 v[118:119], v15 offset:25440
    ds_read_b64_tr_b16 v[120:121], v15 offset:24704
    ds_read_b64_tr_b16 v[122:123], v15 offset:25472
    ds_read_b64_tr_b16 v[124:125], v15 offset:27712
    ds_read_b64_tr_b16 v[126:127], v15 offset:28480
    ds_read_b64_tr_b16 v[128:129], v15 offset:27744
    ds_read_b64_tr_b16 v[130:131], v15 offset:28512
    ds_read_b64_tr_b16 v[132:133], v15 offset:27776
    ds_read_b64_tr_b16 v[134:135], v15 offset:28544
    s_waitcnt lgkmcnt(0)
    v_mfma_f32_32x32x16_bf16 v[64:79], v[112:115], v[16:19], 0
    ds_read_b64_tr_b16 v[136:137], v15 offset:30784
    ds_read_b64_tr_b16 v[138:139], v15 offset:31552
    ds_read_b64_tr_b16 v[140:141], v15 offset:30816
    buffer_store_dwordx4 v[32:35], v177, s[24:27], s44 offen sc1
    s_mov_b32 exec_hi, 0
    buffer_store_dwordx2 v[36:37], v178, s[24:27], s44 offen offset:1024 sc1
    buffer_store_dwordx4 v[38:41], v58, s[24:27], s45 offen sc1
    s_mov_b64 exec, -1
    v_mfma_f32_32x32x16_bf16 v[80:95], v[116:119], v[16:19], 0
    ds_read_b64_tr_b16 v[142:143], v15 offset:31584
    ds_read_b64_tr_b16 v[144:145], v15 offset:30848
    ds_read_b64_tr_b16 v[146:147], v15 offset:31616
    s_mov_b32 exec_lo, 0
    buffer_store_dwordx4 v[36:39], v58, s[24:27], s45 offen sc1
    buffer_store_dwordx2 v[40:41], v60, s[24:27], s45 offen offset:1024 sc1
    s_mov_b64 exec, -1
    v_mfma_f32_32x32x16_bf16 v[96:111], v[120:123], v[16:19], 0
    ds_read_b64_tr_b16 v[148:149], v15 offset:33856
    ds_read_b64_tr_b16 v[150:151], v15 offset:34624
    ds_read_b64_tr_b16 v[152:153], v15 offset:33888
    buffer_store_dwordx4 v[42:45], v59, s[24:27], s46 offen sc1
    s_mov_b32 exec_hi, 0
    buffer_store_dwordx2 v[46:47], v60, s[24:27], s46 offen offset:1024 sc1
    s_mov_b64 exec, -1
    v_mfma_f32_32x32x16_bf16 v[64:79], v[124:127], v[20:23], v[64:79]
    ds_read_b64_tr_b16 v[154:155], v15 offset:34656
    ds_read_b64_tr_b16 v[156:157], v15 offset:33920
    ds_read_b64_tr_b16 v[158:159], v15 offset:34688
    v_mfma_f32_32x32x16_bf16 v[80:95], v[128:131], v[20:23], v[80:95]
    v_mfma_f32_32x32x16_bf16 v[96:111], v[132:135], v[20:23], v[96:111]
    s_cmp_eq_u32 s35, 0
    s_cbranch_scc0 L_rare_k_6
L_back_k_7:
    s_waitcnt vmcnt(12)
L_gw_k_3:
    s_waitcnt lgkmcnt(0)
    s_barrier
    v_mfma_f32_32x32x16_bf16 v[64:79], v[136:139], v[24:27], v[64:79]
    ds_read_b64_tr_b16 v[112:113], v15 offset:49280
    ds_read_b64_tr_b16 v[114:115], v15 offset:50048
    ds_read_b64_tr_b16 v[116:117], v15 offset:49312
    v_mfma_f32_32x32x16_bf16 v[80:95], v[140:143], v[24:27], v[80:95]
    ds_read_b64_tr_b16 v[118:119], v15 offset:50080
    ds_read_b64_tr_b16 v[120:121], v15 offset:49344
    ds_read_b64_tr_b16 v[122:123], v15 offset:50112
    s_add_u32 m0, s100, 24640
    s_add_u32 s67, s72, 589824
    buffer_load_dwordx4 v6, s[12:15], s67 offen lds
    v_mfma_f32_32x32x16_bf16 v[96:111], v[144:147], v[24:27], v[96:111]
    ds_read_b64_tr_b16 v[124:125], v15 offset:52352
    ds_read_b64_tr_b16 v[126:127], v15 offset:53120
    ds_read_b64_tr_b16 v[128:129], v15 offset:52384
    v_mfma_f32_32x32x16_bf16 v[64:79], v[148:151], v[28:31], v[64:79]
    ds_read_b64_tr_b16 v[130:131], v15 offset:53152
    ds_read_b64_tr_b16 v[132:133], v15 offset:52416
    ds_read_b64_tr_b16 v[134:135], v15 offset:53184
    v_mfma_f32_32x32x16_bf16 v[80:95], v[152:155], v[28:31], v[80:95]
    s_add_u32 m0, s101, 24640
    s_add_u32 s67, s72, 589824
    buffer_load_dwordx4 v7, s[20:23], s67 offen lds
    v_mfma_f32_32x32x16_bf16 v[96:111], v[156:159], v[28:31], v[96:111]
    s_branch L_gu11
L_vtype:
    ds_read_b128 v[16:19], v8 offset:0
    ds_read_b64_tr_b16 v[112:113], v12 offset:0
    ds_read_b64_tr_b16 v[114:115], v12 offset:1024
    ds_read_b64_tr_b16 v[116:117], v13 offset:0
    ds_read_b64_tr_b16 v[118:119], v13 offset:1024
    ds_read_b128 v[20:23], v9 offset:0
    ds_read_b64_tr_b16 v[120:121], v12 offset:4096
    ds_read_b64_tr_b16 v[122:123], v12 offset:5120
    ds_read_b64_tr_b16 v[124:125], v13 offset:4096
    ds_read_b64_tr_b16 v[126:127], v13 offset:5120
    s_waitcnt lgkmcnt(0)
    v_mfma_f32_32x32x16_bf16 v[64:79], v[16:19], v[112:115], 0
    ds_read_b128 v[24:27], v10 offset:0
    ds_read_b64_tr_b16 v[136:137], v12 offset:8192
    ds_read_b64_tr_b16 v[138:139], v12 offset:9216
    ds_read_b64_tr_b16 v[140:141], v13 offset:8192
    v_mfma_f32_32x32x16_bf16 v[80:95], v[16:19], v[116:119], 0
    ds_read_b64_tr_b16 v[142:143], v13 offset:9216
    ds_read_b128 v[28:31], v11 offset:0
    ds_read_b64_tr_b16 v[144:145], v12 offset:12288
    ds_read_b64_tr_b16 v[146:147], v12 offset:13312
    v_mfma_f32_32x32x16_bf16 v[64:79], v[20:23], v[120:123], v[64:79]
    ds_read_b64_tr_b16 v[148:149], v13 offset:12288
    ds_read_b64_tr_b16 v[150:151], v13 offset:13312
    v_mfma_f32_32x32x16_bf16 v[80:95], v[20:23], v[124:127], v[80:95]
    s_waitcnt vmcnt(15) lgkmcnt(0)
    s_barrier
    v_mfma_f32_32x32x16_bf16 v[64:79], v[24:27], v[136:139], v[64:79]
    ds_read_b128 v[48:51], v8 offset:16384
    ds_read_b64_tr_b16 v[112:113], v12 offset:24640
    ds_read_b64_tr_b16 v[114:115], v12 offset:25664
    ds_read_b64_tr_b16 v[116:117], v13 offset:24640
    v_mfma_f32_32x32x16_bf16 v[80:95], v[24:27], v[140:143], v[80:95]
    ds_read_b64_tr_b16 v[118:119], v13 offset:25664
    ds_read_b128 v[52:55], v9 offset:16384
    ds_read_b64_tr_b16 v[120:121], v12 offset:28736
    ds_read_b64_tr_b16 v[122:123], v12 offset:29760
    s_add_u32 m0, s74, 0
    s_add_u32 s33, s32, 384
    buffer_load_dwordx4 v4, s[4:7], s33 offen lds
    v_mfma_f32_32x32x16_bf16 v[64:79], v[28:31], v[144:147], v[64:79]
    ds_read_b64_tr_b16 v[124:125], v13 offset:28736
    ds_read_b64_tr_b16 v[126:127], v13 offset:29760
    v_mfma_f32_32x32x16_bf16 v[80:95], v[28:31], v[148:151], v[80:95]
    s_add_u32 m0, s74, 8192
    s_add_u32 s33, s32, 82304
    buffer_load_dwordx4 v4, s[4:7], s33 offen lds
    s_waitcnt lgkmcnt(0)
    v_mfma_f32_32x32x16_bf16 v[64:79], v[48:51], v[112:115], v[64:79]
    ds_read_b128 v[160:163], v10 offset:16384
    ds_read_b64_tr_b16 v[136:137], v12 offset:32832
    ds_read_b64_tr_b16 v[138:139], v12 offset:33856
    ds_read_b64_tr_b16 v[140:141], v13 offset:32832
    v_mfma_f32_32x32x16_bf16 v[80:95], v[48:51], v[116:119], v[80:95]
    ds_read_b64_tr_b16 v[142:143], v13 offset:33856
    ds_read_b128 v[164:167], v11 offset:16384
    ds_read_b64_tr_b16 v[144:145], v12 offset:36928
    ds_read_b64_tr_b16 v[146:147], v12 offset:37952
    s_add_u32 m0, s65, 0
    s_add_u32 s67, s66, 737280
    buffer_load_dwordx4 v5, s[8:11], s67 offen lds
    v_mfma_f32_32x32x16_bf16 v[64:79], v[52:55], v[120:123], v[64:79]
    ds_read_b64_tr_b16 v[148:149], v13 offset:36928
    ds_read_b64_tr_b16 v[150:151], v13 offset:37952
    v_mfma_f32_32x32x16_bf16 v[80:95], v[52:55], v[124:127], v[80:95]
    s_add_u32 m0, s65, 8192
    s_add_u32 s67, s66, 860160
    buffer_load_dwordx4 v5, s[8:11], s67 offen lds
    s_waitcnt vmcnt(15) lgkmcnt(0)
    s_barrier
    v_mfma_f32_32x32x16_bf16 v[64:79], v[160:163], v[136:139], v[64:79]
    ds_read_b128 v[168:171], v8 offset:32768
    ds_read_b64_tr_b16 v[112:113], v12 offset:49280
    ds_read_b64_tr_b16 v[114:115], v12 offset:50304
    ds_read_b64_tr_b16 v[116:117], v13 offset:49280
    v_mfma_f32_32x32x16_bf16 v[80:95], v[160:163], v[140:143], v[80:95]
    ds_read_b64_tr_b16 v[118:119], v13 offset:50304
    ds_read_b128 v[172:175], v9 offset:32768
    ds_read_b64_tr_b16 v[120:121], v12 offset:53376
    ds_read_b64_tr_b16 v[122:123], v12 offset:54400
    s_add_u32 m0, s74, 16384
    s_add_u32 s33, s32, 512
    buffer_load_dwordx4 v4, s[4:7], s33 offen lds
    v_mfma_f32_32x32x16_bf16 v[64:79], v[164:167], v[144:147], v[64:79]
    ds_read_b64_tr_b16 v[124:125], v13 offset:53376
    ds_read_b64_tr_b16 v[126:127], v13 offset:54400
    v_mfma_f32_32x32x16_bf16 v[80:95], v[164:167], v[148:151], v[80:95]
    s_add_u32 m0, s74, 24576
    s_add_u32 s33, s32, 82432
    buffer_load_dwordx4 v4, s[4:7], s33 offen lds
    s_waitcnt lgkmcnt(0)
    v_mfma_f32_32x32x16_bf16 v[64:79], v[168:171], v[112:115], v[64:79]
    ds_read_b128 v[200:203], v10 offset:32768
    ds_read_b64_tr_b16 v[136:137], v12 offset:57472
    ds_read_b64_tr_b16 v[138:139], v12 offset:58496
    ds_read_b64_tr_b16 v[140:141], v13 offset:57472
    v_mfma_f32_32x32x16_bf16 v[80:95], v[168:171], v[116:119], v[80:95]
    ds_read_b64_tr_b16 v[142:143], v13 offset:58496
    ds_read_b128 v[204:207], v11 offset:32768
    ds_read_b64_tr_b16 v[144:145], v12 offset:61568
    ds_read_b64_tr_b16 v[146:147], v12 offset:62592
    s_add_u32 m0, s65, 24640
    s_add_u32 s67, s66, 983040
    buffer_load_dwordx4 v5, s[8:11], s67 offen lds
    v_mfma_f32_32x32x16_bf16 v[64:79], v[172:175], v[120:123], v[64:79]
    ds_read_b64_tr_b16 v[148:149], v13 offset:61568
    ds_read_b64_tr_b16 v[150:151], v13 offset:62592
    v_mfma_f32_32x32x16_bf16 v[80:95], v[172:175], v[124:127], v[80:95]
    s_add_u32 m0, s65, 32832
    s_add_u32 s67, s66, 1105920
    buffer_load_dwordx4 v5, s[8:11], s67 offen lds
    s_waitcnt vmcnt(4) lgkmcnt(0)
    s_barrier
    v_mfma_f32_32x32x16_bf16 v[64:79], v[200:203], v[136:139], v[64:79]
    ds_read_b128 v[208:211], v8 offset:0
    ds_read_b64_tr_b16 v[112:113], v12 offset:0
    ds_read_b64_tr_b16 v[114:115], v12 offset:1024
    ds_read_b64_tr_b16 v[116:117], v13 offset:0
    v_mfma_f32_32x32x16_bf16 v[80:95], v[200:203], v[140:143], v[80:95]
    ds_read_b64_tr_b16 v[118:119], v13 offset:1024
    ds_read_b128 v[212:215], v9 offset:0
    ds_read_b64_tr_b16 v[120:121], v12 offset:4096
    ds_read_b64_tr_b16 v[122:123], v12 offset:5120
    s_add_u32 m0, s74, 32768
    s_add_u32 s33, s32, 640
    buffer_load_dwordx4 v4, s[4:7], s33 offen lds
    v_mfma_f32_32x32x16_bf16 v[64:79], v[204:207], v[144:147], v[64:79]
    ds_read_b64_tr_b16 v[124:125], v13 offset:4096
    ds_read_b64_tr_b16 v[126:127], v13 offset:5120
    v_mfma_f32_32x32x16_bf16 v[80:95], v[204:207], v[148:151], v[80:95]
    s_add_u32 m0, s74, 40960
    s_add_u32 s33, s32, 82560
    buffer_load_dwordx4 v4, s[4:7], s33 offen lds
    s_waitcnt lgkmcnt(0)
    v_mfma_f32_32x32x16_bf16 v[64:79], v[208:211], v[112:115], v[64:79]
    ds_read_b128 v[216:219], v10 offset:0
    ds_read_b64_tr_b16 v[136:137], v12 offset:8192
    ds_read_b64_tr_b16 v[138:139], v12 offset:9216
    ds_read_b64_tr_b16 v[140:141], v13 offset:8192
    v_mov_b32 v56, 0
    v_dot2_f32_bf16 v56, v100, v106, v56
    v_dot2_f32_bf16 v56, v101, v107, v56
    v_dot2_f32_bf16 v56, v102, v108, v56
    v_dot2_f32_bf16 v56, v103, v109, v56
    v_dot2_f32_bf16 v56, v104, v110, v56
    v_mfma_f32_32x32x16_bf16 v[80:95], v[208:211], v[116:119], v[80:95]
    ds_read_b64_tr_b16 v[142:143], v13 offset:9216
    ds_read_b128 v[220:223], v11 offset:0
    ds_read_b64_tr_b16 v[144:145], v12 offset:12288
    ds_read_b64_tr_b16 v[146:147], v12 offset:13312
    s_add_u32 m0, s65, 49280
    s_add_u32 s67, s66, 1228800
    buffer_load_dwordx4 v5, s[8:11], s67 offen lds
    s_nop 3
    v_add_f32_dpp v56, v56, v56 row_shr:1 row_mask:0xf bank_mask:0xf bound_ctrl:0
    s_nop 1
    v_mfma_f32_32x32x16_bf16 v[64:79], v[212:215], v[120:123], v[64:79]
    ds_read_b64_tr_b16 v[148:149], v13 offset:12288
    ds_read_b64_tr_b16 v[150:151], v13 offset:13312
    v_add_f32_dpp v56, v56, v56 row_shr:2 row_mask:0xf bank_mask:0xf bound_ctrl:0
    s_nop 1
    v_add_f32_dpp v56, v56, v56 row_shr:4 row_mask:0xf bank_mask:0xf bound_ctrl:0
    s_nop 1
    v_add_f32_dpp v56, v56, v56 row_shr:8 row_mask:0xf bank_mask:0xf bound_ctrl:0
    s_nop 1
    v_add_f32_dpp v56, v56, v56 row_bcast:15 row_mask:0xa bank_mask:0xf
    s_nop 1
    v_mfma_f32_32x32x16_bf16 v[80:95], v[212:215], v[124:127], v[80:95]
    s_add_u32 m0, s65, 57472
    s_add_u32 s67, s66, 1351680
    buffer_load_dwordx4 v5, s[8:11], s67 offen lds
    v_add_f32_dpp v56, v56, v56 row_bcast:31 row_mask:0xc bank_mask:0xf
    s_nop 1
    v_mul_f32 v56, 0xbfb8aa3b, v56
    v_exp_f32 v56, v56
    s_nop 0
    v_add_f32 v56, 1.0, v56
    v_rcp_f32 v63, v56
    s_waitcnt vmcnt(4) lgkmcnt(0)
    s_barrier
    v_mfma_f32_32x32x16_bf16 v[64:79], v[216:219], v[136:139], v[64:79]
    ds_read_b128 v[224:227], v8 offset:16384
    ds_read_b64_tr_b16 v[112:113], v12 offset:24640
    ds_read_b64_tr_b16 v[114:115], v12 offset:25664
    ds_read_b64_tr_b16 v[116:117], v13 offset:24640
    v_mfma_f32_32x32x16_bf16 v[80:95], v[216:219], v[140:143], v[80:95]
    ds_read_b64_tr_b16 v[118:119], v13 offset:25664
    ds_read_b128 v[228:231], v9 offset:16384
    ds_read_b64_tr_b16 v[120:121], v12 offset:28736
    ds_read_b64_tr_b16 v[122:123], v12 offset:29760
    s_add_u32 m0, s74, 0
    s_add_u32 s33, s32, 768
    buffer_load_dwordx4 v4, s[4:7], s33 offen lds
    v_mfma_f32_32x32x16_bf16 v[64:79], v[220:223], v[144:147], v[64:79]
    ds_read_b64_tr_b16 v[124:125], v13 offset:28736
    ds_read_b64_tr_b16 v[126:127], v13 offset:29760
    v_mfma_f32_32x32x16_bf16 v[80:95], v[220:223], v[148:151], v[80:95]
    s_add_u32 m0, s74, 8192
    s_add_u32 s33, s32, 82688
    buffer_load_dwordx4 v4, s[4:7], s33 offen lds
    s_waitcnt lgkmcnt(0)
    v_mfma_f32_32x32x16_bf16 v[64:79], v[224:227], v[112:115], v[64:79]
    ds_read_b128 v[232:235], v10 offset:16384
    ds_read_b64_tr_b16 v[136:137], v12 offset:32832
    ds_read_b64_tr_b16 v[138:139], v12 offset:33856
    ds_read_b64_tr_b16 v[140:141], v13 offset:32832
    v_mfma_f32_32x32x16_bf16 v[80:95], v[224:227], v[116:119], v[80:95]
    ds_read_b64_tr_b16 v[142:143], v13 offset:33856
    ds_read_b128 v[236:239], v11 offset:16384
    ds_read_b64_tr_b16 v[144:145], v12 offset:36928
    ds_read_b64_tr_b16 v[146:147], v12 offset:37952
    s_add_u32 m0, s65, 0
    s_add_u32 s67, s66, 1474560
    buffer_load_dwordx4 v5, s[8:11], s67 offen lds
    v_mfma_f32_32x32x16_bf16 v[64:79], v[228:231], v[120:123], v[64:79]
    ds_read_b64_tr_b16 v[148:149], v13 offset:36928
    ds_read_b64_tr_b16 v[150:151], v13 offset:37952
    v_mfma_f32_32x32x16_bf16 v[80:95], v[228:231], v[124:127], v[80:95]
    s_add_u32 m0, s65, 8192
    s_add_u32 s67, s66, 1597440
    buffer_load_dwordx4 v5, s[8:11], s67 offen lds
    s_waitcnt vmcnt(4) lgkmcnt(0)
    s_barrier
    v_mfma_f32_32x32x16_bf16 v[64:79], v[232:235], v[136:139], v[64:79]
    ds_read_b128 v[240:243], v8 offset:32768
    ds_read_b64_tr_b16 v[112:113], v12 offset:49280
    ds_read_b64_tr_b16 v[114:115], v12 offset:50304
    ds_read_b64_tr_b16 v[116:117], v13 offset:49280
    v_mfma_f32_32x32x16_bf16 v[80:95], v[232:235], v[140:143], v[80:95]
    ds_read_b64_tr_b16 v[118:119], v13 offset:50304
    ds_read_b128 v[244:247], v9 offset:32768
    ds_read_b64_tr_b16 v[120:121], v12 offset:53376
    ds_read_b64_tr_b16 v[122:123], v12 offset:54400
    s_add_u32 m0, s74, 16384
    s_add_u32 s33, s32, 896
    buffer_load_dwordx4 v4, s[4:7], s33 offen lds
    v_mfma_f32_32x32x16_bf16 v[64:79], v[236:239], v[144:147], v[64:79]
    ds_read_b64_tr_b16 v[124:125], v13 offset:53376
    ds_read_b64_tr_b16 v[126:127], v13 offset:54400
    v_mfma_f32_32x32x16_bf16 v[80:95], v[236:239], v[148:151], v[80:95]
    s_add_u32 m0, s74, 24576
    s_add_u32 s33, s32, 82816
    buffer_load_dwordx4 v4, s[4:7], s33 offen lds
    s_waitcnt lgkmcnt(0)
    v_mfma_f32_32x32x16_bf16 v[64:79], v[240:243], v[112:115], v[64:79]
    ds_read_b128 v[248:251], v10 offset:32768
    ds_read_b64_tr_b16 v[136:137], v12 offset:57472
    ds_read_b64_tr_b16 v[138:139], v12 offset:58496
    ds_read_b64_tr_b16 v[140:141], v13 offset:57472
    v_mfma_f32_32x32x16_bf16 v[80:95], v[240:243], v[116:119], v[80:95]
    ds_read_b64_tr_b16 v[142:143], v13 offset:58496
    ds_read_b128 v[252:255], v11 offset:32768
    ds_read_b64_tr_b16 v[144:145], v12 offset:61568
    ds_read_b64_tr_b16 v[146:147], v12 offset:62592
    s_add_u32 m0, s65, 24640
    s_add_u32 s67, s66, 1720320
    buffer_load_dwordx4 v5, s[8:11], s67 offen lds
    v_mfma_f32_32x32x16_bf16 v[64:79], v[244:247], v[120:123], v[64:79]
    ds_read_b64_tr_b16 v[148:149], v13 offset:61568
    ds_read_b64_tr_b16 v[150:151], v13 offset:62592
    v_mfma_f32_32x32x16_bf16 v[80:95], v[244:247], v[124:127], v[80:95]
    s_add_u32 m0, s65, 32832
    s_add_u32 s67, s66, 1843200
    buffer_load_dwordx4 v5, s[8:11], s67 offen lds
    s_waitcnt vmcnt(4) lgkmcnt(0)
    s_barrier
    v_mfma_f32_32x32x16_bf16 v[64:79], v[248:251], v[136:139], v[64:79]
    ds_read_b128 v[32:35], v8 offset:0
    ds_read_b64_tr_b16 v[112:113], v12 offset:0
    ds_read_b64_tr_b16 v[114:115], v12 offset:1024
    ds_read_b64_tr_b16 v[116:117], v13 offset:0
    v_mfma_f32_32x32x16_bf16 v[80:95], v[248:251], v[140:143], v[80:95]
    ds_read_b64_tr_b16 v[118:119], v13 offset:1024
    ds_read_b128 v[36:39], v9 offset:0
    ds_read_b64_tr_b16 v[120:121], v12 offset:4096
    ds_read_b64_tr_b16 v[122:123], v12 offset:5120
    s_add_u32 m0, s74, 32768
    s_add_u32 s33, s32, 1024
    buffer_load_dwordx4 v4, s[4:7], s33 offen lds
    v_mfma_f32_32x32x16_bf16 v[64:79], v[252:255], v[144:147], v[64:79]
    ds_read_b64_tr_b16 v[124:125], v13 offset:4096
    ds_read_b64_tr_b16 v[126:127], v13 offset:5120
    v_mfma_f32_32x32x16_bf16 v[80:95], v[252:255], v[148:151], v[80:95]
    s_add_u32 m0, s74, 40960
    s_add_u32 s33, s32, 82944
    buffer_load_dwordx4 v4, s[4:7], s33 offen lds
    s_waitcnt lgkmcnt(0)
    v_mfma_f32_32x32x16_bf16 v[64:79], v[32:35], v[112:115], v[64:79]
    ds_read_b128 v[40:43], v10 offset:0
    ds_read_b64_tr_b16 v[136:137], v12 offset:8192
    ds_read_b64_tr_b16 v[138:139], v12 offset:9216
    ds_read_b64_tr_b16 v[140:141], v13 offset:8192
    v_mfma_f32_32x32x16_bf16 v[80:95], v[32:35], v[116:119], v[80:95]
    ds_read_b64_tr_b16 v[142:143], v13 offset:9216
    ds_read_b128 v[44:47], v11 offset:0
    ds_read_b64_tr_b16 v[144:145], v12 offset:12288
    ds_read_b64_tr_b16 v[146:147], v12 offset:13312
    s_add_u32 m0, s65, 49280
    s_add_u32 s67, s66, 1966080
    buffer_load_dwordx4 v5, s[8:11], s67 offen lds
    v_mfma_f32_32x32x16_bf16 v[64:79], v[36:39], v[120:123], v[64:79]
    ds_read_b64_tr_b16 v[148:149], v13 offset:12288
    ds_read_b64_tr_b16 v[150:151], v13 offset:13312
    v_mfma_f32_32x32x16_bf16 v[80:95], v[36:39], v[124:127], v[80:95]
    s_add_u32 m0, s65, 57472
    s_add_u32 s67, s66, 2088960
    buffer_load_dwordx4 v5, s[8:11], s67 offen lds
    s_waitcnt vmcnt(4) lgkmcnt(0)
    s_barrier
    v_mfma_f32_32x32x16_bf16 v[64:79], v[40:43], v[136:139], v[64:79]
    ds_read_b128 v[32:35], v8 offset:16384
    ds_read_b64_tr_b16 v[112:113], v12 offset:24640
    ds_read_b64_tr_b16 v[114:115], v12 offset:25664
    ds_read_b64_tr_b16 v[116:117], v13 offset:24640
    v_mfma_f32_32x32x16_bf16 v[80:95], v[40:43], v[140:143], v[80:95]
    ds_read_b64_tr_b16 v[118:119], v13 offset:25664
    ds_read_b128 v[36:39], v9 offset:16384
    ds_read_b64_tr_b16 v[120:121], v12 offset:28736
    ds_read_b64_tr_b16 v[122:123], v12 offset:29760
    s_add_u32 m0, s74, 0
    s_add_u32 s33, s32, 1152
    buffer_load_dwordx4 v4, s[4:7], s33 offen lds
    v_mfma_f32_32x32x16_bf16 v[64:79], v[44:47], v[144:147], v[64:79]
    ds_read_b64_tr_b16 v[124:125], v13 offset:28736
    ds_read_b64_tr_b16 v[126:127], v13 offset:29760
    v_mfma_f32_32x32x16_bf16 v[80:95], v[44:47], v[148:151], v[80:95]
    s_add_u32 m0, s74, 8192
    s_add_u32 s33, s32, 83072
    buffer_load_dwordx4 v4, s[4:7], s33 offen lds
    s_waitcnt lgkmcnt(0)
    v_mfma_f32_32x32x16_bf16 v[64:79], v[32:35], v[112:115], v[64:79]
    ds_read_b128 v[40:43], v10 offset:16384
    ds_read_b64_tr_b16 v[136:137], v12 offset:32832
    ds_read_b64_tr_b16 v[138:139], v12 offset:33856
    ds_read_b64_tr_b16 v[140:141], v13 offset:32832
    v_mfma_f32_32x32x16_bf16 v[80:95], v[32:35], v[116:119], v[80:95]
    ds_read_b64_tr_b16 v[142:143], v13 offset:33856
    ds_read_b128 v[44:47], v11 offset:16384
    ds_read_b64_tr_b16 v[144:145], v12 offset:36928
    ds_read_b64_tr_b16 v[146:147], v12 offset:37952
    s_add_u32 m0, s65, 0
    s_add_u32 s67, s66, 2211840
    buffer_load_dwordx4 v5, s[8:11], s67 offen lds
    v_mfma_f32_32x32x16_bf16 v[64:79], v[36:39], v[120:123], v[64:79]
    ds_read_b64_tr_b16 v[148:149], v13 offset:36928
    ds_read_b64_tr_b16 v[150:151], v13 offset:37952
    v_mfma_f32_32x32x16_bf16 v[80:95], v[36:39], v[124:127], v[80:95]
    s_add_u32 m0, s65, 8192
    s_add_u32 s67, s66, 2334720
    buffer_load_dwordx4 v5, s[8:11], s67 offen lds
    s_waitcnt vmcnt(4) lgkmcnt(0)
    s_barrier
    v_mfma_f32_32x32x16_bf16 v[64:79], v[40:43], v[136:139], v[64:79]
    ds_read_b128 v[32:35], v8 offset:32768
    ds_read_b64_tr_b16 v[112:113], v12 offset:49280
    ds_read_b64_tr_b16 v[114:115], v12 offset:50304
    ds_read_b64_tr_b16 v[116:117], v13 offset:49280
    v_mfma_f32_32x32x16_bf16 v[80:95], v[40:43], v[140:143], v[80:95]
    ds_read_b64_tr_b16 v[118:119], v13 offset:50304
    ds_read_b128 v[36:39], v9 offset:32768
    ds_read_b64_tr_b16 v[120:121], v12 offset:53376
    ds_read_b64_tr_b16 v[122:123], v12 offset:54400
    s_add_u32 m0, s100, 24640
    s_add_u32 s67, s72, 0
    buffer_load_dwordx4 v6, s[12:15], s67 offen lds
    v_mfma_f32_32x32x16_bf16 v[64:79], v[44:47], v[144:147], v[64:79]
    ds_read_b64_tr_b16 v[124:125], v13 offset:53376
    ds_read_b64_tr_b16 v[126:127], v13 offset:54400
    v_mfma_f32_32x32x16_bf16 v[80:95], v[44:47], v[148:151], v[80:95]
    s_add_u32 m0, s101, 24640
    s_add_u32 s67, s72, 0
    buffer_load_dwordx4 v7, s[20:23], s67 offen lds
    s_waitcnt lgkmcnt(0)
    v_mfma_f32_32x32x16_bf16 v[64:79], v[32:35], v[112:115], v[64:79]
    ds_read_b128 v[40:43], v10 offset:32768
    ds_read_b64_tr_b16 v[136:137], v12 offset:57472
    ds_read_b64_tr_b16 v[138:139], v12 offset:58496
    ds_read_b64_tr_b16 v[140:141], v13 offset:57472
    s_lshl_b32 s70, s56, 2
    s_add_u32 s70, s70, s58
    s_mul_i32 s44, s70, 2560
    s_add_u32 s44, s44, 2622720
    s_sub_u32 s61, s57, 11
    s_lshl_b32 s61, s61, 7
    s_lshl_b32 s62, s59, 6
    s_add_u32 s61, s61, s62
    v_mfma_f32_32x32x16_bf16 v[80:95], v[32:35], v[116:119], v[80:95]
    ds_read_b64_tr_b16 v[142:143], v13 offset:58496
    ds_read_b128 v[44:47], v11 offset:32768
    ds_read_b64_tr_b16 v[144:145], v12 offset:61568
    ds_read_b64_tr_b16 v[146:147], v12 offset:62592
    s_add_u32 m0, s71, 24640
    s_add_u32 s67, s72, 0
    buffer_load_dwordx4 v14, s[16:19], s67 offen lds
    v_and_b32 v56, 31, v1
    v_lshrrev_b32 v57, 5, v1
    v_mul_u32_u24 v57, 320, v57
    v_add_u32 v58, s61, v56
    s_mov_b32 s62, 205
    v_mfma_f32_32x32x16_bf16 v[64:79], v[36:39], v[120:123], v[64:79]
    ds_read_b64_tr_b16 v[148:149], v13 offset:61568
    ds_read_b64_tr_b16 v[150:151], v13 offset:62592
    v_mul_lo_u32 v59, v58, s62
    v_lshrrev_b32 v59, 12, v59
    v_mul_u32_u24 v2, 20, v59
    v_sub_u32 v2, v58, v2
    v_lshlrev_b32 v2, 4, v2
    s_mov_b32 s62, 163840
    v_mul_lo_u32 v59, v59, s62
    v_add3_u32 v60, v59, v2, v57
    v_add_u32 v58, s61, v56
    v_add_u32 v58, 32, v58
    v_mfma_f32_32x32x16_bf16 v[80:95], v[36:39], v[124:127], v[80:95]
    s_mov_b32 s62, 205
    v_mul_lo_u32 v59, v58, s62
    v_lshrrev_b32 v59, 12, v59
    v_mul_u32_u24 v2, 20, v59
    v_sub_u32 v2, v58, v2
    v_lshlrev_b32 v2, 4, v2
    s_mov_b32 s62, 163840
    v_mul_lo_u32 v59, v59, s62
    v_add3_u32 v61, v59, v2, v57
    s_waitcnt vmcnt(3) lgkmcnt(0)
    s_barrier
    v_mfma_f32_32x32x16_bf16 v[64:79], v[40:43], v[136:139], v[64:79]
    ds_read_b128 v[32:35], v8 offset:0
    ds_read_b64_tr_b16 v[112:113], v12 offset:0
    ds_read_b64_tr_b16 v[114:115], v12 offset:1024
    ds_read_b64_tr_b16 v[116:117], v13 offset:0
    v_mfma_f32_32x32x16_bf16 v[80:95], v[40:43], v[140:143], v[80:95]
    ds_read_b64_tr_b16 v[118:119], v13 offset:1024
    ds_read_b128 v[36:39], v9 offset:0
    ds_read_b64_tr_b16 v[120:121], v12 offset:4096
    ds_read_b64_tr_b16 v[122:123], v12 offset:5120
    s_add_u32 m0, s100, 49280
    s_add_u32 s67, s72, 196608
    buffer_load_dwordx4 v6, s[12:15], s67 offen lds
    v_mfma_f32_32x32x16_bf16 v[64:79], v[44:47], v[144:147], v[64:79]
    ds_read_b64_tr_b16 v[124:125], v13 offset:4096
    ds_read_b64_tr_b16 v[126:127], v13 offset:5120
    v_mfma_f32_32x32x16_bf16 v[80:95], v[44:47], v[148:151], v[80:95]
    s_add_u32 m0, s101, 49280
    s_add_u32 s67, s72, 196608
    buffer_load_dwordx4 v7, s[20:23], s67 offen lds
    s_waitcnt lgkmcnt(0)
    v_mfma_f32_32x32x16_bf16 v[64:79], v[32:35], v[112:115], v[64:79]
    ds_read_b128 v[40:43], v10 offset:0
    ds_read_b64_tr_b16 v[136:137], v12 offset:8192
    ds_read_b64_tr_b16 v[138:139], v12 offset:9216
    ds_read_b64_tr_b16 v[140:141], v13 offset:8192
    v_mfma_f32_32x32x16_bf16 v[80:95], v[32:35], v[116:119], v[80:95]
    ds_read_b64_tr_b16 v[142:143], v13 offset:9216
    ds_read_b128 v[44:47], v11 offset:0
    ds_read_b64_tr_b16 v[144:145], v12 offset:12288
    ds_read_b64_tr_b16 v[146:147], v12 offset:13312
    s_add_u32 m0, s71, 49280
    s_add_u32 s67, s72, 196608
    buffer_load_dwordx4 v14, s[16:19], s67 offen lds
    v_mfma_f32_32x32x16_bf16 v[64:79], v[36:39], v[120:123], v[64:79]
    ds_read_b64_tr_b16 v[148:149], v13 offset:12288
    ds_read_b64_tr_b16 v[150:151], v13 offset:13312
    v_mfma_f32_32x32x16_bf16 v[80:95], v[36:39], v[124:127], v[80:95]
    s_waitcnt vmcnt(3) lgkmcnt(0)
    s_barrier
    v_mfma_f32_32x32x16_bf16 v[64:79], v[40:43], v[136:139], v[64:79]
    s_add_u32 m0, s100, 0
    s_add_u32 s67, s72, 393216
    buffer_load_dwordx4 v6, s[12:15], s67 offen lds
    v_mfma_f32_32x32x16_bf16 v[80:95], v[40:43], v[140:143], v[80:95]
    s_add_u32 m0, s101, 0
    s_add_u32 s67, s72, 393216
    buffer_load_dwordx4 v7, s[20:23], s67 offen lds
    v_mfma_f32_32x32x16_bf16 v[64:79], v[44:47], v[144:147], v[64:79]
    s_add_u32 m0, s71, 0
    s_add_u32 s67, s72, 393216
    buffer_load_dwordx4 v14, s[16:19], s67 offen lds
    v_mfma_f32_32x32x16_bf16 v[80:95], v[44:47], v[148:151], v[80:95]
    s_waitcnt lgkmcnt(0)
    s_nop 7
    s_nop 7
    s_mov_b32 s35, 1
    v_cvt_pk_bf16_f32 v32, v64, v65
    v_cvt_pk_bf16_f32 v33, v66, v67
    v_cvt_pk_bf16_f32 v34, v68, v69
    v_cvt_pk_bf16_f32 v35, v70, v71
    v_cvt_pk_bf16_f32 v36, v72, v73
    v_cvt_pk_bf16_f32 v37, v74, v75
    v_cvt_pk_bf16_f32 v38, v76, v77
    v_cvt_pk_bf16_f32 v39, v78, v79
    v_cvt_pk_bf16_f32 v40, v80, v81
    v_cvt_pk_bf16_f32 v41, v82, v83
    v_cvt_pk_bf16_f32 v42, v84, v85
    v_cvt_pk_bf16_f32 v43, v86, v87
    v_cvt_pk_bf16_f32 v44, v88, v89
    v_cvt_pk_bf16_f32 v45, v90, v91
    v_cvt_pk_bf16_f32 v46, v92, v93
    v_cvt_pk_bf16_f32 v47, v94, v95
    v_mov_b32 v3, 0
    s_mov_b32 exec_lo, 0
    s_mov_b32 exec_hi, 0x80000000
    buffer_store_dword v63, v3, s[24:27], s0 offen sc1
    s_mov_b64 exec, -1
    buffer_load_dword v62, v3, s[28:31], 0 offen sc1
    ds_read_b64_tr_b16 v[112:113], v15 offset:24640
    ds_read_b64_tr_b16 v[114:115], v15 offset:25408
    ds_read_b64_tr_b16 v[116:117], v15 offset:24672
    ds_read_b64_tr_b16 v[118:119], v15 offset:25440
    ds_read_b64_tr_b16 v[120:121], v15 offset:24704
    ds_read_b64_tr_b16 v[122:123], v15 offset:25472
    ds_read_b64_tr_b16 v[124:125], v15 offset:27712
    ds_read_b64_tr_b16 v[126:127], v15 offset:28480
    ds_read_b64_tr_b16 v[128:129], v15 offset:27744
    ds_read_b64_tr_b16 v[130:131], v15 offset:28512
    ds_read_b64_tr_b16 v[132:133], v15 offset:27776
    ds_read_b64_tr_b16 v[134:135], v15 offset:28544
    s_waitcnt lgkmcnt(0)
    v_mfma_f32_32x32x16_bf16 v[64:79], v[112:115], v[16:19], 0
    ds_read_b64_tr_b16 v[136:137], v15 offset:30784
    ds_read_b64_tr_b16 v[138:139], v15 offset:31552
    ds_read_b64_tr_b16 v[140:141], v15 offset:30816
    v_mfma_f32_32x32x16_bf16 v[80:95], v[116:119], v[16:19], 0
    ds_read_b64_tr_b16 v[142:143], v15 offset:31584
    ds_read_b64_tr_b16 v[144:145], v15 offset:30848
    ds_read_b64_tr_b16 v[146:147], v15 offset:31616
    v_mfma_f32_32x32x16_bf16 v[96:111], v[120:123], v[16:19], 0
    ds_read_b64_tr_b16 v[148:149], v15 offset:33856
    ds_read_b64_tr_b16 v[150:151], v15 offset:34624
    ds_read_b64_tr_b16 v[152:153], v15 offset:33888
    v_mfma_f32_32x32x16_bf16 v[64:79], v[124:127], v[20:23], v[64:79]
    ds_read_b64_tr_b16 v[154:155], v15 offset:34656
    ds_read_b64_tr_b16 v[156:157], v15 offset:33920
    ds_read_b64_tr_b16 v[158:159], v15 offset:34688
    v_mfma_f32_32x32x16_bf16 v[80:95], v[128:131], v[20:23], v[80:95]
    buffer_store_dwordx4 v[32:35], v60, s[24:27], s44 offen offset:0 sc1
    buffer_store_dwordx4 v[36:39], v60, s[24:27], s44 offen offset:640 sc1
    buffer_store_dwordx4 v[40:43], v61, s[24:27], s44 offen offset:0 sc1
    v_mfma_f32_32x32x16_bf16 v[96:111], v[132:135], v[20:23], v[96:111]
    buffer_store_dwordx4 v[44:47], v61, s[24:27], s44 offen offset:640 sc1
    s_cmp_eq_u32 s35, 0
    s_cbranch_scc0 L_rare_k_11
L_back_k_12:
    s_waitcnt vmcnt(12)
L_gw_k_8:
    s_waitcnt lgkmcnt(0)
    s_barrier
    v_mfma_f32_32x32x16_bf16 v[64:79], v[136:139], v[24:27], v[64:79]
    ds_read_b64_tr_b16 v[112:113], v15 offset:49280
    ds_read_b64_tr_b16 v[114:115], v15 offset:50048
    ds_read_b64_tr_b16 v[116:117], v15 offset:49312
    v_mfma_f32_32x32x16_bf16 v[80:95], v[140:143], v[24:27], v[80:95]
    ds_read_b64_tr_b16 v[118:119], v15 offset:50080
    ds_read_b64_tr_b16 v[120:121], v15 offset:49344
    ds_read_b64_tr_b16 v[122:123], v15 offset:50112
    s_add_u32 m0, s100, 24640
    s_add_u32 s67, s72, 589824
    buffer_load_dwordx4 v6, s[12:15], s67 offen lds
    v_mfma_f32_32x32x16_bf16 v[96:111], v[144:147], v[24:27], v[96:111]
    ds_read_b64_tr_b16 v[124:125], v15 offset:52352
    ds_read_b64_tr_b16 v[126:127], v15 offset:53120
    ds_read_b64_tr_b16 v[128:129], v15 offset:52384
    v_mfma_f32_32x32x16_bf16 v[64:79], v[148:151], v[28:31], v[64:79]
    ds_read_b64_tr_b16 v[130:131], v15 offset:53152
    ds_read_b64_tr_b16 v[132:133], v15 offset:52416
    ds_read_b64_tr_b16 v[134:135], v15 offset:53184
    v_mfma_f32_32x32x16_bf16 v[80:95], v[152:155], v[28:31], v[80:95]
    s_add_u32 m0, s101, 24640
    s_add_u32 s67, s72, 589824
    buffer_load_dwordx4 v7, s[20:23], s67 offen lds
    v_mfma_f32_32x32x16_bf16 v[96:111], v[156:159], v[28:31], v[96:111]
L_gu11:
    s_waitcnt lgkmcnt(0)
    v_mfma_f32_32x32x16_bf16 v[64:79], v[112:115], v[48:51], v[64:79]
    ds_read_b64_tr_b16 v[136:137], v15 offset:55424
    ds_read_b64_tr_b16 v[138:139], v15 offset:56192
    ds_read_b64_tr_b16 v[140:141], v15 offset:55456
    v_mfma_f32_32x32x16_bf16 v[80:95], v[116:119], v[48:51], v[80:95]
    ds_read_b64_tr_b16 v[142:143], v15 offset:56224
    ds_read_b64_tr_b16 v[144:145], v15 offset:55488
    ds_read_b64_tr_b16 v[146:147], v15 offset:56256
    s_add_u32 m0, s71, 24640
    s_add_u32 s67, s72, 589824
    buffer_load_dwordx4 v14, s[16:19], s67 offen lds
    v_mfma_f32_32x32x16_bf16 v[96:111], v[120:123], v[48:51], v[96:111]
    ds_read_b64_tr_b16 v[148:149], v15 offset:58496
    ds_read_b64_tr_b16 v[150:151], v15 offset:59264
    ds_read_b64_tr_b16 v[152:153], v15 offset:58528
    v_mfma_f32_32x32x16_bf16 v[64:79], v[124:127], v[52:55], v[64:79]
    ds_read_b64_tr_b16 v[154:155], v15 offset:59296
    ds_read_b64_tr_b16 v[156:157], v15 offset:58560
    ds_read_b64_tr_b16 v[158:159], v15 offset:59328
    v_mfma_f32_32x32x16_bf16 v[80:95], v[128:131], v[52:55], v[80:95]
    v_mfma_f32_32x32x16_bf16 v[96:111], v[132:135], v[52:55], v[96:111]
    s_cmp_eq_u32 s35, 0
    s_cbranch_scc0 L_rare_k_16
L_back_k_17:
    s_waitcnt vmcnt(12)
L_gw_k_13:
    s_waitcnt lgkmcnt(0)
    s_barrier
    v_mfma_f32_32x32x16_bf16 v[64:79], v[136:139], v[160:163], v[64:79]
    ds_read_b64_tr_b16 v[112:113], v15 offset:0
    ds_read_b64_tr_b16 v[114:115], v15 offset:768
    ds_read_b64_tr_b16 v[116:117], v15 offset:32
    v_mfma_f32_32x32x16_bf16 v[80:95], v[140:143], v[160:163], v[80:95]
    ds_read_b64_tr_b16 v[118:119], v15 offset:800
    ds_read_b64_tr_b16 v[120:121], v15 offset:64
    ds_read_b64_tr_b16 v[122:123], v15 offset:832
    s_add_u32 m0, s100, 49280
    s_add_u32 s67, s72, 786432
    buffer_load_dwordx4 v6, s[12:15], s67 offen lds
    v_mfma_f32_32x32x16_bf16 v[96:111], v[144:147], v[160:163], v[96:111]
    ds_read_b64_tr_b16 v[124:125], v15 offset:3072
    ds_read_b64_tr_b16 v[126:127], v15 offset:3840
    ds_read_b64_tr_b16 v[128:129], v15 offset:3104
    v_mfma_f32_32x32x16_bf16 v[64:79], v[148:151], v[164:167], v[64:79]
    ds_read_b64_tr_b16 v[130:131], v15 offset:3872
    ds_read_b64_tr_b16 v[132:133], v15 offset:3136
    ds_read_b64_tr_b16 v[134:135], v15 offset:3904
    v_mfma_f32_32x32x16_bf16 v[80:95], v[152:155], v[164:167], v[80:95]
    s_add_u32 m0, s101, 49280
    s_add_u32 s67, s72, 786432
    buffer_load_dwordx4 v7, s[20:23], s67 offen lds
    v_mfma_f32_32x32x16_bf16 v[96:111], v[156:159], v[164:167], v[96:111]
    s_waitcnt lgkmcnt(0)
    v_mfma_f32_32x32x16_bf16 v[64:79], v[112:115], v[168:171], v[64:79]
    ds_read_b64_tr_b16 v[136:137], v15 offset:6144
    ds_read_b64_tr_b16 v[138:139], v15 offset:6912
    ds_read_b64_tr_b16 v[140:141], v15 offset:6176
    v_mfma_f32_32x32x16_bf16 v[80:95], v[116:119], v[168:171], v[80:95]
    ds_read_b64_tr_b16 v[142:143], v15 offset:6944
    ds_read_b64_tr_b16 v[144:145], v15 offset:6208
    ds_read_b64_tr_b16 v[146:147], v15 offset:6976
    s_add_u32 m0, s71, 49280
    s_add_u32 s67, s72, 786432
    buffer_load_dwordx4 v14, s[16:19], s67 offen lds
    v_mfma_f32_32x32x16_bf16 v[96:111], v[120:123], v[168:171], v[96:111]
    ds_read_b64_tr_b16 v[148:149], v15 offset:9216
    ds_read_b64_tr_b16 v[150:151], v15 offset:9984
    ds_read_b64_tr_b16 v[152:153], v15 offset:9248
    v_mfma_f32_32x32x16_bf16 v[64:79], v[124:127], v[172:175], v[64:79]
    ds_read_b64_tr_b16 v[154:155], v15 offset:10016
    ds_read_b64_tr_b16 v[156:157], v15 offset:9280
    ds_read_b64_tr_b16 v[158:159], v15 offset:10048
    v_mfma_f32_32x32x16_bf16 v[80:95], v[128:131], v[172:175], v[80:95]
    v_mfma_f32_32x32x16_bf16 v[96:111], v[132:135], v[172:175], v[96:111]
    s_waitcnt vmcnt(3) lgkmcnt(0)
    s_barrier
    v_mfma_f32_32x32x16_bf16 v[64:79], v[136:139], v[200:203], v[64:79]
    ds_read_b64_tr_b16 v[112:113], v15 offset:24640
    ds_read_b64_tr_b16 v[114:115], v15 offset:25408
    ds_read_b64_tr_b16 v[116:117], v15 offset:24672
    v_mfma_f32_32x32x16_bf16 v[80:95], v[140:143], v[200:203], v[80:95]
    ds_read_b64_tr_b16 v[118:119], v15 offset:25440
    ds_read_b64_tr_b16 v[120:121], v15 offset:24704
    ds_read_b64_tr_b16 v[122:123], v15 offset:25472
    s_add_u32 m0, s100, 0
    s_add_u32 s67, s72, 983040
    buffer_load_dwordx4 v6, s[12:15], s67 offen lds
    v_mfma_f32_32x32x16_bf16 v[96:111], v[144:147], v[200:203], v[96:111]
    ds_read_b64_tr_b16 v[124:125], v15 offset:27712
    ds_read_b64_tr_b16 v[126:127], v15 offset:28480
    ds_read_b64_tr_b16 v[128:129], v15 offset:27744
    v_mfma_f32_32x32x16_bf16 v[64:79], v[148:151], v[204:207], v[64:79]
    ds_read_b64_tr_b16 v[130:131], v15 offset:28512
    ds_read_b64_tr_b16 v[132:133], v15 offset:27776
    ds_read_b64_tr_b16 v[134:135], v15 offset:28544
    v_mfma_f32_32x32x16_bf16 v[80:95], v[152:155], v[204:207], v[80:95]
    s_add_u32 m0, s101, 0
    s_add_u32 s67, s72, 983040
    buffer_load_dwordx4 v7, s[20:23], s67 offen lds
    v_mfma_f32_32x32x16_bf16 v[96:111], v[156:159], v[204:207], v[96:111]
    s_cmp_eq_u32 s3, 0
    s_cbranch_scc1 L_rare_k_18
L_back_k_19:
    s_waitcnt lgkmcnt(0)
    v_mfma_f32_32x32x16_bf16 v[64:79], v[112:115], v[208:211], v[64:79]
    ds_read_b64_tr_b16 v[136:137], v15 offset:30784
    ds_read_b64_tr_b16 v[138:139], v15 offset:31552
    ds_read_b64_tr_b16 v[140:141], v15 offset:30816
    s_mov_b32 s0, s48
    s_mov_b32 s1, s49
    s_and_b32 s61, s2, 7
    s_lshr_b32 s62, s2, 3
    v_mfma_f32_32x32x16_bf16 v[80:95], v[116:119], v[208:211], v[80:95]
    ds_read_b64_tr_b16 v[142:143], v15 offset:31584
    ds_read_b64_tr_b16 v[144:145], v15 offset:30848
    ds_read_b64_tr_b16 v[146:147], v15 offset:31616
    s_add_u32 m0, s71, 0
    s_add_u32 s67, s72, 983040
    buffer_load_dwordx4 v14, s[16:19], s67 offen lds
    s_lshl_b32 s61, s61, 2
    v_mfma_f32_32x32x16_bf16 v[96:111], v[120:123], v[208:211], v[96:111]
    ds_read_b64_tr_b16 v[148:149], v15 offset:33856
    ds_read_b64_tr_b16 v[150:151], v15 offset:34624
    ds_read_b64_tr_b16 v[152:153], v15 offset:33888
    s_lshr_b32 s48, s62, 3
    s_add_u32 s48, s48, s61
    s_and_b32 s62, s62, 7
    s_lshl_b32 s62, s62, 3
    v_mfma_f32_32x32x16_bf16 v[64:79], v[124:127], v[212:215], v[64:79]
    ds_read_b64_tr_b16 v[154:155], v15 offset:34656
    ds_read_b64_tr_b16 v[156:157], v15 offset:33920
    ds_read_b64_tr_b16 v[158:159], v15 offset:34688
    s_lshl_b32 s61, s58, 1
    s_add_u32 s49, s62, s61
    s_mov_b32 s38, s40
    s_mov_b32 s39, s41
    v_mfma_f32_32x32x16_bf16 v[80:95], v[128:131], v[212:215], v[80:95]
    s_add_u32 s40, s54, 2621440
    s_addc_u32 s41, s55, 0
    s_and_b32 s41, s41, 0xffff
    s_mov_b32 s42, 5242880
    s_mov_b32 s43, 0x20000
    s_sub_i32 s61, s3, 2
    s_max_i32 s61, s61, 0
    v_mfma_f32_32x32x16_bf16 v[96:111], v[132:135], v[212:215], v[96:111]
    s_min_i32 s61, s61, 4
    s_lshl_b32 s62, s61, 10
    s_add_u32 s65, s62, 122880
    s_mul_i32 s51, s48, 163840
    s_waitcnt vmcnt(3) lgkmcnt(0)
    s_barrier
    v_mfma_f32_32x32x16_bf16 v[64:79], v[136:139], v[216:219], v[64:79]
    ds_read_b64_tr_b16 v[112:113], v15 offset:49280
    ds_read_b64_tr_b16 v[114:115], v15 offset:50048
    ds_read_b64_tr_b16 v[116:117], v15 offset:49312
    v_mfma_f32_32x32x16_bf16 v[80:95], v[140:143], v[216:219], v[80:95]
    ds_read_b64_tr_b16 v[118:119], v15 offset:50080
    ds_read_b64_tr_b16 v[120:121], v15 offset:49344
    ds_read_b64_tr_b16 v[122:123], v15 offset:50112
    s_add_u32 m0, s74, 16384
    s_add_u32 s33, s32, 768
    buffer_load_dwordx4 v4, s[4:7], s33 offen lds
    v_mfma_f32_32x32x16_bf16 v[96:111], v[144:147], v[216:219], v[96:111]
    ds_read_b64_tr_b16 v[124:125], v15 offset:52352
    ds_read_b64_tr_b16 v[126:127], v15 offset:53120
    ds_read_b64_tr_b16 v[128:129], v15 offset:52384
    v_mfma_f32_32x32x16_bf16 v[64:79], v[148:151], v[220:223], v[64:79]
    ds_read_b64_tr_b16 v[130:131], v15 offset:53152
    ds_read_b64_tr_b16 v[132:133], v15 offset:52416
    ds_read_b64_tr_b16 v[134:135], v15 offset:53184
    v_mfma_f32_32x32x16_bf16 v[80:95], v[152:155], v[220:223], v[80:95]
    s_add_u32 m0, s74, 24576
    s_add_u32 s33, s32, 82688
    buffer_load_dwordx4 v4, s[4:7], s33 offen lds
    v_mfma_f32_32x32x16_bf16 v[96:111], v[156:159], v[220:223], v[96:111]
    s_waitcnt lgkmcnt(0)
    v_mfma_f32_32x32x16_bf16 v[64:79], v[112:115], v[224:227], v[64:79]
    ds_read_b64_tr_b16 v[136:137], v15 offset:55424
    ds_read_b64_tr_b16 v[138:139], v15 offset:56192
    ds_read_b64_tr_b16 v[140:141], v15 offset:55456
    s_add_u32 m0, s100, 24640
    s_add_u32 s67, s72, 1179648
    buffer_load_dwordx4 v6, s[12:15], s67 offen lds
    v_mfma_f32_32x32x16_bf16 v[80:95], v[116:119], v[224:227], v[80:95]
    ds_read_b64_tr_b16 v[142:143], v15 offset:56224
    ds_read_b64_tr_b16 v[144:145], v15 offset:55488
    ds_read_b64_tr_b16 v[146:147], v15 offset:56256
    v_mfma_f32_32x32x16_bf16 v[96:111], v[120:123], v[224:227], v[96:111]
    ds_read_b64_tr_b16 v[148:149], v15 offset:58496
    ds_read_b64_tr_b16 v[150:151], v15 offset:59264
    ds_read_b64_tr_b16 v[152:153], v15 offset:58528
    s_add_u32 m0, s101, 24640
    s_add_u32 s67, s72, 1179648
    buffer_load_dwordx4 v7, s[20:23], s67 offen lds
    v_mfma_f32_32x32x16_bf16 v[64:79], v[124:127], v[228:231], v[64:79]
    ds_read_b64_tr_b16 v[154:155], v15 offset:59296
    ds_read_b64_tr_b16 v[156:157], v15 offset:58560
    ds_read_b64_tr_b16 v[158:159], v15 offset:59328
    v_mfma_f32_32x32x16_bf16 v[80:95], v[128:131], v[228:231], v[80:95]
    s_add_u32 m0, s71, 24640
    s_add_u32 s67, s72, 1179648
    buffer_load_dwordx4 v14, s[16:19], s67 offen lds
    v_mfma_f32_32x32x16_bf16 v[96:111], v[132:135], v[228:231], v[96:111]
    s_waitcnt vmcnt(5) lgkmcnt(0)
    s_barrier
    v_mfma_f32_32x32x16_bf16 v[64:79], v[136:139], v[232:235], v[64:79]
    ds_read_b64_tr_b16 v[112:113], v15 offset:0
    ds_read_b64_tr_b16 v[114:115], v15 offset:768
    ds_read_b64_tr_b16 v[116:117], v15 offset:32
    v_mfma_f32_32x32x16_bf16 v[80:95], v[140:143], v[232:235], v[80:95]
    ds_read_b64_tr_b16 v[118:119], v15 offset:800
    ds_read_b64_tr_b16 v[120:121], v15 offset:64
    ds_read_b64_tr_b16 v[122:123], v15 offset:832
    s_add_u32 m0, s74, 32768
    s_add_u32 s33, s32, 896
    buffer_load_dwordx4 v4, s[4:7], s33 offen lds
    v_mfma_f32_32x32x16_bf16 v[96:111], v[144:147], v[232:235], v[96:111]
    ds_read_b64_tr_b16 v[124:125], v15 offset:3072
    ds_read_b64_tr_b16 v[126:127], v15 offset:3840
    ds_read_b64_tr_b16 v[128:129], v15 offset:3104
    v_mfma_f32_32x32x16_bf16 v[64:79], v[148:151], v[236:239], v[64:79]
    ds_read_b64_tr_b16 v[130:131], v15 offset:3872
    ds_read_b64_tr_b16 v[132:133], v15 offset:3136
    ds_read_b64_tr_b16 v[134:135], v15 offset:3904
    v_mfma_f32_32x32x16_bf16 v[80:95], v[152:155], v[236:239], v[80:95]
    s_add_u32 m0, s74, 40960
    s_add_u32 s33, s32, 82816
    buffer_load_dwordx4 v4, s[4:7], s33 offen lds
    v_mfma_f32_32x32x16_bf16 v[96:111], v[156:159], v[236:239], v[96:111]
    s_waitcnt lgkmcnt(0)
    v_mfma_f32_32x32x16_bf16 v[64:79], v[112:115], v[240:243], v[64:79]
    ds_read_b64_tr_b16 v[136:137], v15 offset:6144
    ds_read_b64_tr_b16 v[138:139], v15 offset:6912
    ds_read_b64_tr_b16 v[140:141], v15 offset:6176
    s_add_u32 m0, s100, 49280
    s_add_u32 s67, s72, 1376256
    buffer_load_dwordx4 v6, s[12:15], s67 offen lds
    v_mfma_f32_32x32x16_bf16 v[80:95], v[116:119], v[240:243], v[80:95]
    ds_read_b64_tr_b16 v[142:143], v15 offset:6944
    ds_read_b64_tr_b16 v[144:145], v15 offset:6208
    ds_read_b64_tr_b16 v[146:147], v15 offset:6976
    v_mfma_f32_32x32x16_bf16 v[96:111], v[120:123], v[240:243], v[96:111]
    ds_read_b64_tr_b16 v[148:149], v15 offset:9216
    ds_read_b64_tr_b16 v[150:151], v15 offset:9984
    ds_read_b64_tr_b16 v[152:153], v15 offset:9248
    s_add_u32 m0, s101, 49280
    s_add_u32 s67, s72, 1376256
    buffer_load_dwordx4 v7, s[20:23], s67 offen lds
    v_mfma_f32_32x32x16_bf16 v[64:79], v[124:127], v[244:247], v[64:79]
    ds_read_b64_tr_b16 v[154:155], v15 offset:10016
    ds_read_b64_tr_b16 v[156:157], v15 offset:9280
    ds_read_b64_tr_b16 v[158:159], v15 offset:10048
    v_mfma_f32_32x32x16_bf16 v[80:95], v[128:131], v[244:247], v[80:95]
    s_add_u32 m0, s71, 49280
    s_add_u32 s67, s72, 1376256
    buffer_load_dwordx4 v14, s[16:19], s67 offen lds
    v_mfma_f32_32x32x16_bf16 v[96:111], v[132:135], v[244:247], v[96:111]
    s_waitcnt vmcnt(5) lgkmcnt(0)
    s_barrier
    v_mfma_f32_32x32x16_bf16 v[64:79], v[136:139], v[248:251], v[64:79]
    ds_read_b128 v[32:35], v8 offset:16384
    ds_read_b64_tr_b16 v[112:113], v15 offset:24640
    ds_read_b64_tr_b16 v[114:115], v15 offset:25408
    v_mfma_f32_32x32x16_bf16 v[80:95], v[140:143], v[248:251], v[80:95]
    ds_read_b64_tr_b16 v[116:117], v15 offset:24672
    ds_read_b64_tr_b16 v[118:119], v15 offset:25440
    ds_read_b64_tr_b16 v[120:121], v15 offset:24704
    s_add_u32 m0, s74, 0
    s_add_u32 s33, s32, 1024
    buffer_load_dwordx4 v4, s[4:7], s33 offen lds
    v_mfma_f32_32x32x16_bf16 v[96:111], v[144:147], v[248:251], v[96:111]
    ds_read_b64_tr_b16 v[122:123], v15 offset:25472
    ds_read_b128 v[36:39], v9 offset:16384
    ds_read_b64_tr_b16 v[124:125], v15 offset:27712
    v_mfma_f32_32x32x16_bf16 v[64:79], v[148:151], v[252:255], v[64:79]
    ds_read_b64_tr_b16 v[126:127], v15 offset:28480
    ds_read_b64_tr_b16 v[128:129], v15 offset:27744
    ds_read_b64_tr_b16 v[130:131], v15 offset:28512
    v_mfma_f32_32x32x16_bf16 v[80:95], v[152:155], v[252:255], v[80:95]
    ds_read_b64_tr_b16 v[132:133], v15 offset:27776
    ds_read_b64_tr_b16 v[134:135], v15 offset:28544
    s_add_u32 m0, s74, 8192
    s_add_u32 s33, s32, 82944
    buffer_load_dwordx4 v4, s[4:7], s33 offen lds
    v_mfma_f32_32x32x16_bf16 v[96:111], v[156:159], v[252:255], v[96:111]
    s_waitcnt lgkmcnt(0)
    v_mfma_f32_32x32x16_bf16 v[64:79], v[112:115], v[32:35], v[64:79]
    ds_read_b128 v[40:43], v10 offset:16384
    ds_read_b64_tr_b16 v[136:137], v15 offset:30784
    ds_read_b64_tr_b16 v[138:139], v15 offset:31552
    s_add_u32 m0, s100, 0
    s_add_u32 s67, s72, 1572864
    buffer_load_dwordx4 v6, s[12:15], s67 offen lds
    v_and_b32 v56, 31, v1
    v_cmp_eq_u32 vcc, 20, v56
    v_mfma_f32_32x32x16_bf16 v[80:95], v[116:119], v[32:35], v[80:95]
    ds_read_b64_tr_b16 v[140:141], v15 offset:30816
    ds_read_b64_tr_b16 v[142:143], v15 offset:31584
    ds_read_b64_tr_b16 v[144:145], v15 offset:30848
    v_mov_b32 v57, 0x3f803f80
    s_nop 0
    v_cndmask_b32 v58, 0, v57, vcc
    v_mov_b32 v24, v58
    v_mov_b32 v25, v58
    v_mfma_f32_32x32x16_bf16 v[96:111], v[120:123], v[32:35], v[96:111]
    ds_read_b64_tr_b16 v[146:147], v15 offset:31616
    ds_read_b128 v[44:47], v11 offset:16384
    ds_read_b64_tr_b16 v[148:149], v15 offset:33856
    s_add_u32 m0, s101, 0
    s_add_u32 s67, s72, 1572864
    buffer_load_dwordx4 v7, s[20:23], s67 offen lds
    v_mov_b32 v26, v58
    v_mov_b32 v27, v58
    v_mfma_f32_32x32x16_bf16 v[64:79], v[124:127], v[36:39], v[64:79]
    ds_read_b64_tr_b16 v[150:151], v15 offset:34624
    ds_read_b64_tr_b16 v[152:153], v15 offset:33888
    ds_read_b64_tr_b16 v[154:155], v15 offset:34656
    v_mov_b32 v28, v58
    v_mov_b32 v29, v58
    v_mov_b32 v30, v58
    v_mov_b32 v31, v58
    v_mov_b32 v22, 0x3f803f80
    v_mfma_f32_32x32x16_bf16 v[80:95], v[128:131], v[36:39], v[80:95]
    ds_read_b64_tr_b16 v[156:157], v15 offset:33920
    ds_read_b64_tr_b16 v[158:159], v15 offset:34688
    s_add_u32 m0, s71, 0
    s_add_u32 s67, s72, 1572864
    buffer_load_dwordx4 v14, s[16:19], s67 offen lds
    v_mov_b32 v23, 0x3f80
    v_mov_b32 v48, 0
    v_mov_b32 v49, 0
    v_mfma_f32_32x32x16_bf16 v[96:111], v[132:135], v[36:39], v[96:111]
    v_mov_b32 v50, 0
    v_mov_b32 v51, 0
    v_mov_b32 v52, 0
    v_mov_b32 v53, 0
    v_mov_b32 v54, 0
    v_mov_b32 v55, 0
    s_waitcnt vmcnt(5) lgkmcnt(0)
    s_barrier
    v_mfma_f32_32x32x16_bf16 v[64:79], v[136:139], v[40:43], v[64:79]
    ds_read_b128 v[32:35], v8 offset:32768
    ds_read_b64_tr_b16 v[112:113], v15 offset:49280
    ds_read_b64_tr_b16 v[114:115], v15 offset:50048
    v_mov_b32 v216, 0
    v_mov_b32 v217, 0
    v_mov_b32 v218, 0
    v_mov_b32 v219, 0
    v_mov_b32 v220, 0
    v_mov_b32 v221, 0
    v_mfma_f32_32x32x16_bf16 v[80:95], v[140:143], v[40:43], v[80:95]
    ds_read_b64_tr_b16 v[116:117], v15 offset:49312
    ds_read_b64_tr_b16 v[118:119], v15 offset:50080
    ds_read_b64_tr_b16 v[120:121], v15 offset:49344
    s_add_u32 m0, s74, 16384
    s_add_u32 s33, s32, 1152
    buffer_load_dwordx4 v4, s[4:7], s33 offen lds
    v_mov_b32 v222, 0
    v_mov_b32 v223, 0
    v_mov_b32 v224, 0
    v_mfma_f32_32x32x16_bf16 v[96:111], v[144:147], v[40:43], v[96:111]
    ds_read_b64_tr_b16 v[122:123], v15 offset:50112
    ds_read_b128 v[36:39], v9 offset:32768
    ds_read_b64_tr_b16 v[124:125], v15 offset:52352
    v_mov_b32 v225, 0
    v_mov_b32 v226, 0
    v_mov_b32 v227, 0
    v_mov_b32 v228, 0
    v_mov_b32 v229, 0
    v_mov_b32 v230, 0
    v_mfma_f32_32x32x16_bf16 v[64:79], v[148:151], v[44:47], v[64:79]
    ds_read_b64_tr_b16 v[126:127], v15 offset:53120
    ds_read_b64_tr_b16 v[128:129], v15 offset:52384
    ds_read_b64_tr_b16 v[130:131], v15 offset:53152
    v_mov_b32 v231, 0
    v_mov_b32 v232, 0
    v_mov_b32 v233, 0
    v_mov_b32 v234, 0
    v_mov_b32 v235, 0
    v_mov_b32 v236, 0
    v_mfma_f32_32x32x16_bf16 v[80:95], v[152:155], v[44:47], v[80:95]
    ds_read_b64_tr_b16 v[132:133], v15 offset:52416
    ds_read_b64_tr_b16 v[134:135], v15 offset:53184
    s_add_u32 m0, s74, 24576
    s_add_u32 s33, s32, 83072
    buffer_load_dwordx4 v4, s[4:7], s33 offen lds
    v_mov_b32 v237, 0
    v_mov_b32 v238, 0
    v_mov_b32 v239, 0
    v_mov_b32 v240, 0
    v_mfma_f32_32x32x16_bf16 v[96:111], v[156:159], v[44:47], v[96:111]
    v_mov_b32 v241, 0
    v_mov_b32 v242, 0
    v_mov_b32 v243, 0
    v_mov_b32 v244, 0
    v_mov_b32 v245, 0
    v_mov_b32 v246, 0
    v_mov_b32 v247, 0
    s_waitcnt lgkmcnt(0)
    v_mfma_f32_32x32x16_bf16 v[64:79], v[112:115], v[32:35], v[64:79]
    ds_read_b128 v[40:43], v10 offset:32768
    ds_read_b64_tr_b16 v[136:137], v15 offset:55424
    ds_read_b64_tr_b16 v[138:139], v15 offset:56192
    s_add_u32 m0, s100, 24640
    s_add_u32 s67, s72, 1769472
    buffer_load_dwordx4 v6, s[12:15], s67 offen lds
    v_mfma_f32_32x32x16_bf16 v[80:95], v[116:119], v[32:35], v[80:95]
    ds_read_b64_tr_b16 v[140:141], v15 offset:55456
    ds_read_b64_tr_b16 v[142:143], v15 offset:56224
    ds_read_b64_tr_b16 v[144:145], v15 offset:55488
    v_mfma_f32_32x32x16_bf16 v[96:111], v[120:123], v[32:35], v[96:111]
    ds_read_b64_tr_b16 v[146:147], v15 offset:56256
    ds_read_b128 v[44:47], v11 offset:32768
    ds_read_b64_tr_b16 v[148:149], v15 offset:58496
    s_add_u32 m0, s101, 24640
    s_add_u32 s67, s72, 1769472
    buffer_load_dwordx4 v7, s[20:23], s67 offen lds
    v_mfma_f32_32x32x16_bf16 v[64:79], v[124:127], v[36:39], v[64:79]
    ds_read_b64_tr_b16 v[150:151], v15 offset:59264
    ds_read_b64_tr_b16 v[152:153], v15 offset:58528
    ds_read_b64_tr_b16 v[154:155], v15 offset:59296
    v_mfma_f32_32x32x16_bf16 v[80:95], v[128:131], v[36:39], v[80:95]
    ds_read_b64_tr_b16 v[156:157], v15 offset:58560
    ds_read_b64_tr_b16 v[158:159], v15 offset:59328
    s_add_u32 m0, s71, 24640
    s_add_u32 s67, s72, 1769472
    buffer_load_dwordx4 v14, s[16:19], s67 offen lds
    v_mfma_f32_32x32x16_bf16 v[96:111], v[132:135], v[36:39], v[96:111]
    s_waitcnt vmcnt(5) lgkmcnt(0)
    s_barrier
    v_mfma_f32_32x32x16_bf16 v[64:79], v[136:139], v[40:43], v[64:79]
    ds_read_b128 v[32:35], v8 offset:0
    ds_read_b64_tr_b16 v[112:113], v15 offset:0
    ds_read_b64_tr_b16 v[114:115], v15 offset:768
    s_and_b32 s61, s2, 7
    s_lshr_b32 s62, s2, 3
    s_lshr_b32 s44, s61, 1
    s_lshl_b32 s44, s44, 3
    s_and_b32 s63, s62, 7
    s_add_u32 s44, s44, s63
    v_mfma_f32_32x32x16_bf16 v[80:95], v[140:143], v[40:43], v[80:95]
    ds_read_b64_tr_b16 v[116:117], v15 offset:32
    ds_read_b64_tr_b16 v[118:119], v15 offset:800
    ds_read_b64_tr_b16 v[120:121], v15 offset:64
    s_and_b32 s45, s61, 1
    s_lshl_b32 s45, s45, 2
    s_lshr_b32 s63, s62, 3
    s_add_u32 s45, s45, s63
    s_lshl_b32 s32, s44, 1
    s_lshr_b32 s61, s58, 1
    v_mfma_f32_32x32x16_bf16 v[96:111], v[144:147], v[40:43], v[96:111]
    ds_read_b64_tr_b16 v[122:123], v15 offset:832
    ds_read_b128 v[36:39], v9 offset:0
    ds_read_b64_tr_b16 v[124:125], v15 offset:3072
    s_add_u32 s32, s32, s61
    s_mov_b32 s4, s0
    s_mov_b32 s5, s1
    s_and_b32 s5, s5, 0xffff
    s_mov_b32 s6, 1966080
    s_mov_b32 s7, 0x20000
    v_mfma_f32_32x32x16_bf16 v[64:79], v[148:151], v[44:47], v[64:79]
    ds_read_b64_tr_b16 v[126:127], v15 offset:3840
    ds_read_b64_tr_b16 v[128:129], v15 offset:3104
    ds_read_b64_tr_b16 v[130:131], v15 offset:3872
    s_mov_b32 s8, s38
    s_mov_b32 s9, s39
    s_and_b32 s9, s9, 0xffff
    s_mov_b32 s10, 819200
    s_mov_b32 s11, 0x20000
    s_mov_b32 s12, s52
    v_mfma_f32_32x32x16_bf16 v[80:95], v[152:155], v[44:47], v[80:95]
    ds_read_b64_tr_b16 v[132:133], v15 offset:3136
    ds_read_b64_tr_b16 v[134:135], v15 offset:3904
    s_mov_b32 s13, s53
    s_and_b32 s13, s13, 0xffff
    s_mov_b32 s14, 2621440
    s_mov_b32 s15, 0x20000
    s_mov_b32 s16, s4
    s_mov_b32 s17, s5
    s_mov_b32 s18, s6
    v_mfma_f32_32x32x16_bf16 v[96:111], v[156:159], v[44:47], v[96:111]
    s_mov_b32 s19, s7
    s_cmp_lt_u32 s3, 2
    s_cselect_b32 s20, s4, s40
    s_cselect_b32 s21, s5, s41
    s_cselect_b32 s22, s6, s42
    s_cselect_b32 s23, s7, s43
    s_cselect_b32 s38, 1, 0
    s_cmp_eq_u32 s3, 0
    s_cbranch_scc1 L_rare_k_20
L_back_k_21:
    s_waitcnt lgkmcnt(0)
    v_mfma_f32_32x32x16_bf16 v[64:79], v[112:115], v[32:35], v[64:79]
    ds_read_b128 v[40:43], v10 offset:0
    ds_read_b64_tr_b16 v[136:137], v15 offset:6144
    ds_read_b64_tr_b16 v[138:139], v15 offset:6912
    s_mul_i32 s72, s45, 160
    s_cmp_ge_u32 s3, 5
    s_cselect_b32 s73, 1, 0
    v_mfma_f32_32x32x16_bf16 v[80:95], v[116:119], v[32:35], v[80:95]
    ds_read_b64_tr_b16 v[140:141], v15 offset:6176
    ds_read_b64_tr_b16 v[142:143], v15 offset:6944
    ds_read_b64_tr_b16 v[144:145], v15 offset:6208
    s_mul_i32 s61, s73, 5
    s_sub_u32 s61, s3, s61
    s_mul_i32 s33, s73, 5120
    v_mfma_f32_32x32x16_bf16 v[96:111], v[120:123], v[32:35], v[96:111]
    ds_read_b64_tr_b16 v[146:147], v15 offset:6976
    ds_read_b128 v[44:47], v11 offset:0
    ds_read_b64_tr_b16 v[148:149], v15 offset:9216
    s_lshl_b32 s61, s61, 10
    s_add_u32 s33, s33, s61
    s_mul_i32 s67, s73, 40960
    v_mfma_f32_32x32x16_bf16 v[64:79], v[124:127], v[36:39], v[64:79]
    ds_read_b64_tr_b16 v[150:151], v15 offset:9984
    ds_read_b64_tr_b16 v[152:153], v15 offset:9248
    ds_read_b64_tr_b16 v[154:155], v15 offset:10016
    s_add_u32 s67, s67, s72
    s_mov_b32 s74, 81920
    s_mul_i32 s71, s32, 98304
    v_mfma_f32_32x32x16_bf16 v[80:95], v[128:131], v[36:39], v[80:95]
    ds_read_b64_tr_b16 v[156:157], v15 offset:9280
    ds_read_b64_tr_b16 v[158:159], v15 offset:10048
    s_lshl_b32 s61, s59, 11
    s_add_u32 s71, s71, s61
    s_add_u32 s71, s71, 7864320
    s_mov_b32 s0, 0xfffff
    v_mfma_f32_32x32x16_bf16 v[96:111], v[132:135], v[36:39], v[96:111]
    s_mov_b32 s1, 0xfffff
    s_mov_b32 s46, 0
    s_mov_b32 s47, 0
    s_mov_b32 s37, 0
    s_mov_b32 s34, 0
    s_mov_b32 s36, 0xffffb000
    s_waitcnt vmcnt(0) lgkmcnt(0)
    s_cmp_eq_u32 s3, 0
    s_cbranch_scc1 L_rare_k_22
L_back_k_23:
    s_barrier
    v_mfma_f32_32x32x16_bf16 v[64:79], v[136:139], v[40:43], v[64:79]
    ds_read_b128 v[32:35], v8 offset:16384
    ds_read_b64_tr_b16 v[112:113], v15 offset:24640
    ds_read_b64_tr_b16 v[114:115], v15 offset:25408
    s_lshl_b32 s61, s48, 6
    s_add_u32 s61, s61, s49
    s_add_u32 s61, s61, 0
    s_mul_i32 s61, s61, 1280
    buffer_load_dwordx4 v[160:163], v177, s[24:27], s61 offen sc1
    buffer_load_dwordx2 v[164:165], v178, s[24:27], s61 offen offset:1024 sc1
    s_lshl_b32 s61, s48, 6
    v_mfma_f32_32x32x16_bf16 v[80:95], v[140:143], v[40:43], v[80:95]
    ds_read_b64_tr_b16 v[116:117], v15 offset:24672
    ds_read_b64_tr_b16 v[118:119], v15 offset:25440
    ds_read_b64_tr_b16 v[120:121], v15 offset:24704
    s_add_u32 s61, s61, s49
    s_add_u32 s61, s61, 1
    s_mul_i32 s61, s61, 1280
    buffer_load_dwordx4 v[168:171], v177, s[24:27], s61 offen sc1
    buffer_load_dwordx2 v[172:173], v178, s[24:27], s61 offen offset:1024 sc1
    s_add_u32 s61, s49, s59
    s_lshl_b32 s61, s61, 7
    v_mfma_f32_32x32x16_bf16 v[96:111], v[144:147], v[40:43], v[96:111]
    ds_read_b64_tr_b16 v[122:123], v15 offset:25472
    ds_read_b128 v[36:39], v9 offset:16384
    ds_read_b64_tr_b16 v[124:125], v15 offset:27712
    s_add_u32 s61, s61, 16777216
    buffer_load_dword v176, v176, s[24:27], s61 offen sc1
    s_add_u32 m0, s65, 20480
    s_nop 0
    buffer_load_dwordx4 v192, s[40:43], s51 offen sc1 lds
    s_add_u32 s51, s51, 2560
    s_add_u32 m0, s65, 25600
    s_nop 0
    buffer_load_dwordx4 v192, s[40:43], s51 offen sc1 lds
    v_mfma_f32_32x32x16_bf16 v[64:79], v[148:151], v[44:47], v[64:79]
    ds_read_b64_tr_b16 v[126:127], v15 offset:28480
    ds_read_b64_tr_b16 v[128:129], v15 offset:27744
    ds_read_b64_tr_b16 v[130:131], v15 offset:28512
    s_add_u32 s51, s51, 2560
    s_add_u32 m0, s65, 30720
    s_nop 0
    buffer_load_dwordx4 v192, s[40:43], s51 offen sc1 lds
    s_add_u32 s51, s51, 2560
    s_add_u32 m0, s65, 35840
    s_nop 0
    buffer_load_dwordx4 v192, s[40:43], s51 offen sc1 lds
    v_mfma_f32_32x32x16_bf16 v[80:95], v[152:155], v[44:47], v[80:95]
    ds_read_b64_tr_b16 v[132:133], v15 offset:27776
    ds_read_b64_tr_b16 v[134:135], v15 offset:28544
    s_add_u32 s51, s51, 2560
    s_add_u32 m0, s65, 0
    s_nop 0
    buffer_load_dwordx4 v192, s[40:43], s51 offen sc1 lds
    s_add_u32 s51, s51, 2560
    s_add_u32 m0, s65, 5120
    s_nop 0
    buffer_load_dwordx4 v192, s[40:43], s51 offen sc1 lds
    v_mfma_f32_32x32x16_bf16 v[96:111], v[156:159], v[44:47], v[96:111]
    s_add_u32 s51, s51, 2560
    s_lshl_b32 s61, s32, 7
    s_add_u32 s61, s61, 16777216
    buffer_load_dword v187, v187, s[24:27], s61 offen sc1
    s_waitcnt lgkmcnt(0)
    v_mfma_f32_32x32x16_bf16 v[64:79], v[112:115], v[32:35], v[64:79]
    ds_read_b128 v[40:43], v10 offset:16384
    ds_read_b64_tr_b16 v[136:137], v15 offset:30784
    ds_read_b64_tr_b16 v[138:139], v15 offset:31552
    s_add_u32 s61, s3, 3
    s_min_u32 s61, s61, 4
    v_mfma_f32_32x32x16_bf16 v[80:95], v[116:119], v[32:35], v[80:95]
    ds_read_b64_tr_b16 v[140:141], v15 offset:30816
    ds_read_b64_tr_b16 v[142:143], v15 offset:31584
    ds_read_b64_tr_b16 v[144:145], v15 offset:30848
    s_lshl_b32 s61, s61, 10
    s_add_u32 s61, s61, 5120
    v_mfma_f32_32x32x16_bf16 v[96:111], v[120:123], v[32:35], v[96:111]
    ds_read_b64_tr_b16 v[146:147], v15 offset:31616
    ds_read_b128 v[44:47], v11 offset:16384
    ds_read_b64_tr_b16 v[148:149], v15 offset:33856
    s_cmp_lt_u32 s3, 2
    s_cselect_b32 s66, s61, s65
    v_mfma_f32_32x32x16_bf16 v[64:79], v[124:127], v[36:39], v[64:79]
    ds_read_b64_tr_b16 v[150:151], v15 offset:34624
    ds_read_b64_tr_b16 v[152:153], v15 offset:33888
    ds_read_b64_tr_b16 v[154:155], v15 offset:34656
    s_add_u32 s61, s72, 40960
    s_cmp_lt_u32 s3, 2
    s_cselect_b32 s69, s61, s51
    v_mfma_f32_32x32x16_bf16 v[80:95], v[128:131], v[36:39], v[80:95]
    ds_read_b64_tr_b16 v[156:157], v15 offset:33920
    ds_read_b64_tr_b16 v[158:159], v15 offset:34688
    s_mov_b32 s61, 81920
    s_cmp_lt_u32 s3, 2
    s_cselect_b32 s70, s61, 2560
    v_mfma_f32_32x32x16_bf16 v[96:111], v[132:135], v[36:39], v[96:111]
    s_mov_b32 s64, 0
    s_waitcnt lgkmcnt(0)
    s_barrier
    v_mfma_f32_32x32x16_bf16 v[64:79], v[136:139], v[40:43], v[64:79]
    v_mfma_f32_32x32x16_bf16 v[80:95], v[140:143], v[40:43], v[80:95]
    v_mfma_f32_32x32x16_bf16 v[96:111], v[144:147], v[40:43], v[96:111]
    v_mfma_f32_32x32x16_bf16 v[64:79], v[148:151], v[44:47], v[64:79]
    v_mfma_f32_32x32x16_bf16 v[80:95], v[152:155], v[44:47], v[80:95]
    v_mfma_f32_32x32x16_bf16 v[96:111], v[156:159], v[44:47], v[96:111]
    s_waitcnt lgkmcnt(0)
    s_nop 7
    s_nop 7
    s_mov_b32 s61, 0xc0135761
    s_mov_b32 s62, 0xbdd2d3e8
    s_lshl_b32 s100, s56, 2
    s_add_u32 s100, s100, s58
    s_mul_i32 s101, s100, 96
    s_mul_i32 s63, s57, 6
    s_add_u32 s101, s101, s63
    s_mul_i32 s63, s59, 3
    s_add_u32 s101, s101, s63
    s_lshl_b32 s101, s101, 10
    s_add_u32 s101, s101, 7864320
    v_mov_b32 v61, s61
    v_mul_f32 v32, v64, v64
    v_mul_f32 v33, v65, v65
    v_mul_f32 v34, v66, v66
    v_mul_f32 v35, v67, v67
    v_mul_f32 v36, v68, v68
    v_mul_f32 v37, v69, v69
    v_mul_f32 v38, v70, v70
    v_mul_f32 v39, v71, v71
    v_fma_f32 v32, v32, s62, v61
    v_fma_f32 v33, v33, s62, v61
    v_fma_f32 v34, v34, s62, v61
    v_fma_f32 v35, v35, s62, v61
    v_fma_f32 v36, v36, s62, v61
    v_fma_f32 v37, v37, s62, v61
    v_fma_f32 v38, v38, s62, v61
    v_fma_f32 v39, v39, s62, v61
    v_mul_f32 v32, v32, v64
    v_mul_f32 v33, v33, v65
    v_mul_f32 v34, v34, v66
    v_mul_f32 v35, v35, v67
    v_mul_f32 v36, v36, v68
    v_mul_f32 v37, v37, v69
    v_mul_f32 v38, v38, v70
    v_mul_f32 v39, v39, v71
    v_exp_f32 v32, v32
    v_exp_f32 v33, v33
    v_exp_f32 v34, v34
    v_exp_f32 v35, v35
    v_exp_f32 v36, v36
    v_exp_f32 v37, v37
    v_exp_f32 v38, v38
    v_exp_f32 v39, v39
    v_mul_f32 v72, v64, v72
    v_mul_f32 v73, v65, v73
    v_mul_f32 v74, v66, v74
    v_mul_f32 v75, v67, v75
    v_mul_f32 v76, v68, v76
    v_mul_f32 v77, v69, v77
    v_mul_f32 v78, v70, v78
    v_mul_f32 v79, v71, v79
    v_add_f32 v32, 1.0, v32
    v_add_f32 v33, 1.0, v33
    v_add_f32 v34, 1.0, v34
    v_add_f32 v35, 1.0, v35
    v_add_f32 v36, 1.0, v36
    v_add_f32 v37, 1.0, v37
    v_add_f32 v38, 1.0, v38
    v_add_f32 v39, 1.0, v39
    v_rcp_f32 v32, v32
    v_rcp_f32 v33, v33
    v_rcp_f32 v34, v34
    v_rcp_f32 v35, v35
    v_rcp_f32 v36, v36
    v_rcp_f32 v37, v37
    v_rcp_f32 v38, v38
    v_rcp_f32 v39, v39
    s_nop 0
    v_mul_f32 v72, v72, v32
    v_mul_f32 v73, v73, v33
    v_mul_f32 v74, v74, v34
    v_mul_f32 v75, v75, v35
    v_mul_f32 v76, v76, v36
    v_mul_f32 v77, v77, v37
    v_mul_f32 v78, v78, v38
    v_mul_f32 v79, v79, v39
    v_cvt_pk_bf16_f32 v40, v72, v73
    v_cvt_pk_bf16_f32 v41, v74, v75
    v_cvt_pk_bf16_f32 v42, v76, v77
    v_cvt_pk_bf16_f32 v43, v78, v79
    buffer_store_dwordx4 v[40:43], v177, s[24:27], s101 offen offset:0 sc1
    v_mul_f32 v32, v80, v80
    v_mul_f32 v33, v81, v81
    v_mul_f32 v34, v82, v82
    v_mul_f32 v35, v83, v83
    v_mul_f32 v36, v84, v84
    v_mul_f32 v37, v85, v85
    v_mul_f32 v38, v86, v86
    v_mul_f32 v39, v87, v87
    v_fma_f32 v32, v32, s62, v61
    v_fma_f32 v33, v33, s62, v61
    v_fma_f32 v34, v34, s62, v61
    v_fma_f32 v35, v35, s62, v61
    v_fma_f32 v36, v36, s62, v61
    v_fma_f32 v37, v37, s62, v61
    v_fma_f32 v38, v38, s62, v61
    v_fma_f32 v39, v39, s62, v61
    v_mul_f32 v32, v32, v80
    v_mul_f32 v33, v33, v81
    v_mul_f32 v34, v34, v82
    v_mul_f32 v35, v35, v83
    v_mul_f32 v36, v36, v84
    v_mul_f32 v37, v37, v85
    v_mul_f32 v38, v38, v86
    v_mul_f32 v39, v39, v87
    v_exp_f32 v32, v32
    v_exp_f32 v33, v33
    v_exp_f32 v34, v34
    v_exp_f32 v35, v35
    v_exp_f32 v36, v36
    v_exp_f32 v37, v37
    v_exp_f32 v38, v38
    v_exp_f32 v39, v39
    v_mul_f32 v88, v80, v88
    v_mul_f32 v89, v81, v89
    v_mul_f32 v90, v82, v90
    v_mul_f32 v91, v83, v91
    v_mul_f32 v92, v84, v92
    v_mul_f32 v93, v85, v93
    v_mul_f32 v94, v86, v94
    v_mul_f32 v95, v87, v95
    v_add_f32 v32, 1.0, v32
    v_add_f32 v33, 1.0, v33
    v_add_f32 v34, 1.0, v34
    v_add_f32 v35, 1.0, v35
    v_add_f32 v36, 1.0, v36
    v_add_f32 v37, 1.0, v37
    v_add_f32 v38, 1.0, v38
    v_add_f32 v39, 1.0, v39
    v_rcp_f32 v32, v32
    v_rcp_f32 v33, v33
    v_rcp_f32 v34, v34
    v_rcp_f32 v35, v35
    v_rcp_f32 v36, v36
    v_rcp_f32 v37, v37
    v_rcp_f32 v38, v38
    v_rcp_f32 v39, v39
    s_nop 0
    v_mul_f32 v88, v88, v32
    v_mul_f32 v89, v89, v33
    v_mul_f32 v90, v90, v34
    v_mul_f32 v91, v91, v35
    v_mul_f32 v92, v92, v36
    v_mul_f32 v93, v93, v37
    v_mul_f32 v94, v94, v38
    v_mul_f32 v95, v95, v39
    v_cvt_pk_bf16_f32 v44, v88, v89
    v_cvt_pk_bf16_f32 v45, v90, v91
    v_cvt_pk_bf16_f32 v46, v92, v93
    v_cvt_pk_bf16_f32 v47, v94, v95
    buffer_store_dwordx4 v[44:47], v177, s[24:27], s101 offen offset:1024 sc1
    v_mul_f32 v32, v96, v96
    v_mul_f32 v33, v97, v97
    v_mul_f32 v34, v98, v98
    v_mul_f32 v35, v99, v99
    v_mul_f32 v36, v100, v100
    v_mul_f32 v37, v101, v101
    v_mul_f32 v38, v102, v102
    v_mul_f32 v39, v103, v103
    v_fma_f32 v32, v32, s62, v61
    v_fma_f32 v33, v33, s62, v61
    v_fma_f32 v34, v34, s62, v61
    v_fma_f32 v35, v35, s62, v61
    v_fma_f32 v36, v36, s62, v61
    v_fma_f32 v37, v37, s62, v61
    v_fma_f32 v38, v38, s62, v61
    v_fma_f32 v39, v39, s62, v61
    v_mul_f32 v32, v32, v96
    v_mul_f32 v33, v33, v97
    v_mul_f32 v34, v34, v98
    v_mul_f32 v35, v35, v99
    v_mul_f32 v36, v36, v100
    v_mul_f32 v37, v37, v101
    v_mul_f32 v38, v38, v102
    v_mul_f32 v39, v39, v103
    v_exp_f32 v32, v32
    v_exp_f32 v33, v33
    v_exp_f32 v34, v34
    v_exp_f32 v35, v35
    v_exp_f32 v36, v36
    v_exp_f32 v37, v37
    v_exp_f32 v38, v38
    v_exp_f32 v39, v39
    v_mul_f32 v104, v96, v104
    v_mul_f32 v105, v97, v105
    v_mul_f32 v106, v98, v106
    v_mul_f32 v107, v99, v107
    v_mul_f32 v108, v100, v108
    v_mul_f32 v109, v101, v109
    v_mul_f32 v110, v102, v110
    v_mul_f32 v111, v103, v111
    v_add_f32 v32, 1.0, v32
    v_add_f32 v33, 1.0, v33
    v_add_f32 v34, 1.0, v34
    v_add_f32 v35, 1.0, v35
    v_add_f32 v36, 1.0, v36
    v_add_f32 v37, 1.0, v37
    v_add_f32 v38, 1.0, v38
    v_add_f32 v39, 1.0, v39
    v_rcp_f32 v32, v32
    v_rcp_f32 v33, v33
    v_rcp_f32 v34, v34
    v_rcp_f32 v35, v35
    v_rcp_f32 v36, v36
    v_rcp_f32 v37, v37
    v_rcp_f32 v38, v38
    v_rcp_f32 v39, v39
    s_nop 0
    v_mul_f32 v104, v104, v32
    v_mul_f32 v105, v105, v33
    v_mul_f32 v106, v106, v34
    v_mul_f32 v107, v107, v35
    v_mul_f32 v108, v108, v36
    v_mul_f32 v109, v109, v37
    v_mul_f32 v110, v110, v38
    v_mul_f32 v111, v111, v39
    v_cvt_pk_bf16_f32 v56, v104, v105
    v_cvt_pk_bf16_f32 v57, v106, v107
    v_cvt_pk_bf16_f32 v58, v108, v109
    v_cvt_pk_bf16_f32 v59, v110, v111
    buffer_store_dwordx4 v[56:59], v177, s[24:27], s101 offen offset:2048 sc1
    v_mov_b32 v3, 0
    v_readfirstlane_b32 s60, v62
    s_nop 3
    s_cmp_lg_u32 s60, 0
    s_cbranch_scc1 L_nk_k_24
    s_mov_b32 s75, 0
L_spn_k_25:
    buffer_load_dword v62, v3, s[28:31], 0 offen sc1
    s_waitcnt vmcnt(0)
    v_readfirstlane_b32 s60, v62
    s_nop 3
    s_cmp_lg_u32 s60, 0
    s_cbranch_scc1 L_spdn_k_26
    s_add_u32 s75, s75, 1
    s_cmp_ge_u32 s75, 131072
    s_cbranch_scc1 L_spdn_k_26
    s_sleep 2
    s_branch L_spn_k_25
L_spdn_k_26:
L_nk_k_24:
    v_mov_b32 v112, 0
    v_mov_b32 v113, 0
    v_mov_b32 v114, 0
    v_mov_b32 v115, 0
    v_mov_b32 v116, 0
    v_mov_b32 v117, 0
    v_mov_b32 v118, 0
    v_mov_b32 v119, 0
    v_mov_b32 v120, 0
    v_mov_b32 v121, 0
    v_mov_b32 v122, 0
    v_mov_b32 v123, 0
    v_mov_b32 v124, 0
    v_mov_b32 v125, 0
    v_mov_b32 v126, 0
    v_mov_b32 v127, 0
    v_mov_b32 v128, 0
    v_mov_b32 v129, 0
    v_mov_b32 v130, 0
    v_mov_b32 v131, 0
    v_mov_b32 v110, 0
    v_mov_b32 v111, 0
    s_waitcnt vmcnt(3)
    v_cmp_gt_u32 vcc, 32, v1
    s_nop 1
    v_cndmask_b32 v164, 0, v164, vcc
    v_cndmask_b32 v165, 0, v165, vcc
    v_mov_b32 v166, 0
    v_mov_b32 v167, 0
    v_cndmask_b32 v172, 0, v172, vcc
    v_cndmask_b32 v173, 0, v173, vcc
    v_mov_b32 v174, 0
    v_mov_b32 v175, 0
    s_barrier
    ds_read_b128 v[16:19], v179 offset:0
    ds_read_b64 v[20:21], v180 offset:0
    s_waitcnt lgkmcnt(0)
    v_mfma_f32_32x32x16_bf16 v[64:79], v[16:19], v[160:163], 0
    v_mfma_f32_32x32x16_bf16 v[64:79], v[20:23], v[164:167], v[64:79]
    s_nop 7
    s_nop 7
    s_cmp_lt_u32 s3, 2
    s_cbranch_scc1 L_p2W
    s_mov_b32 s68, s33
    s_mov_b32 s50, s33
    s_mov_b32 s52, s66
    s_add_u32 s53, s66, 20480
L_alphaK:
    s_setprio 3
    v_mfma_f32_32x32x16_bf16 v[80:95], v[16:19], v[168:171], 0
    ds_read_b128 v[16:19], v179 offset:5120
    v_exp_f32 v96, v64
    v_exp_f32 v97, v65
    v_cvt_pk_bf16_f32 v55, v110, v111
    v_exp_f32 v98, v66
    v_exp_f32 v99, v67
    v_cvt_pk_bf16_f32 v48, v96, v97
    v_mfma_f32_32x32x16_bf16 v[232:247], v[28:31], v[52:55], v[232:247]
    s_mov_b64 exec, s[0:1]
    ds_read_b128 v[24:27], v181 offset:0
    ds_read_b128 v[28:31], v181 offset:640
    s_mov_b64 exec, -1
    v_exp_f32 v100, v68
    v_exp_f32 v101, v69
    v_cvt_pk_bf16_f32 v49, v98, v99
    v_exp_f32 v102, v70
    v_exp_f32 v103, v71
    v_cvt_pk_bf16_f32 v50, v100, v101
    v_mfma_f32_32x32x16_bf16 v[80:95], v[20:23], v[172:175], v[80:95]
    ds_read_b64 v[20:21], v180 offset:5120
    v_exp_f32 v104, v72
    v_exp_f32 v105, v73
    v_cvt_pk_bf16_f32 v51, v102, v103
    v_exp_f32 v106, v74
    v_exp_f32 v107, v75
    v_cvt_pk_bf16_f32 v52, v104, v105
    s_waitcnt lgkmcnt(2)
    v_mfma_f32_32x32x16_bf16 v[216:231], v[24:27], v[48:51], v[216:231]
    s_add_u32 m0, s68, 0
    v_exp_f32 v108, v76
    v_exp_f32 v109, v77
    v_cvt_pk_bf16_f32 v53, v106, v107
    buffer_load_dwordx4 v185, s[16:19], s67 offen lds
    v_exp_f32 v110, v78
    v_exp_f32 v111, v79
    v_cvt_pk_bf16_f32 v54, v108, v109
    s_add_u32 s67, s67, s74
    s_waitcnt lgkmcnt(0)
    s_setprio 2
    v_mfma_f32_32x32x16_bf16 v[64:79], v[16:19], v[160:163], 0
    v_exp_f32 v96, v80
    v_exp_f32 v97, v81
    v_cvt_pk_bf16_f32 v55, v110, v111
    v_exp_f32 v98, v82
    v_exp_f32 v99, v83
    v_cvt_pk_bf16_f32 v48, v96, v97
    v_mfma_f32_32x32x16_bf16 v[216:231], v[28:31], v[52:55], v[216:231]
    v_exp_f32 v100, v84
    v_exp_f32 v101, v85
    v_cvt_pk_bf16_f32 v49, v98, v99
    v_exp_f32 v102, v86
    v_exp_f32 v103, v87
    v_cvt_pk_bf16_f32 v50, v100, v101
    v_mfma_f32_32x32x16_bf16 v[64:79], v[20:23], v[164:167], v[64:79]
    v_exp_f32 v104, v88
    v_exp_f32 v105, v89
    v_cvt_pk_bf16_f32 v51, v102, v103
    v_exp_f32 v106, v90
    v_exp_f32 v107, v91
    v_cvt_pk_bf16_f32 v52, v104, v105
    v_mfma_f32_32x32x16_bf16 v[232:247], v[24:27], v[48:51], v[232:247]
    s_add_u32 m0, s52, 10240
    v_exp_f32 v108, v92
    v_exp_f32 v109, v93
    v_cvt_pk_bf16_f32 v53, v106, v107
    buffer_load_dwordx4 v186, s[20:23], s69 offen sc1 lds
    v_exp_f32 v110, v94
    v_exp_f32 v111, v95
    v_cvt_pk_bf16_f32 v54, v108, v109
    s_add_u32 s69, s69, s70
    s_setprio 1
    v_mfma_f32_32x32x16_bf16 v[80:95], v[16:19], v[168:171], 0
    ds_read_b128 v[16:19], v179 offset:10240
    v_exp_f32 v96, v64
    v_exp_f32 v97, v65
    v_cvt_pk_bf16_f32 v55, v110, v111
    v_exp_f32 v98, v66
    v_exp_f32 v99, v67
    v_cvt_pk_bf16_f32 v48, v96, v97
    v_mfma_f32_32x32x16_bf16 v[232:247], v[28:31], v[52:55], v[232:247]
    s_mov_b64 exec, s[0:1]
    ds_read_b128 v[24:27], v181 offset:5120
    ds_read_b128 v[28:31], v181 offset:5760
    s_mov_b64 exec, -1
    v_exp_f32 v100, v68
    v_exp_f32 v101, v69
    v_cvt_pk_bf16_f32 v49, v98, v99
    v_exp_f32 v102, v70
    v_exp_f32 v103, v71
    v_cvt_pk_bf16_f32 v50, v100, v101
    v_mfma_f32_32x32x16_bf16 v[80:95], v[20:23], v[172:175], v[80:95]
    ds_read_b64 v[20:21], v180 offset:10240
    v_exp_f32 v104, v72
    v_exp_f32 v105, v73
    v_cvt_pk_bf16_f32 v51, v102, v103
    v_exp_f32 v106, v74
    v_exp_f32 v107, v75
    v_cvt_pk_bf16_f32 v52, v104, v105
    s_waitcnt lgkmcnt(2)
    v_mfma_f32_32x32x16_bf16 v[216:231], v[24:27], v[48:51], v[216:231]
    s_add_u32 m0, s68, 10240
    v_exp_f32 v108, v76
    v_exp_f32 v109, v77
    v_cvt_pk_bf16_f32 v53, v106, v107
    buffer_load_dwordx4 v185, s[16:19], s67 offen lds
    v_exp_f32 v110, v78
    v_exp_f32 v111, v79
    v_cvt_pk_bf16_f32 v54, v108, v109
    s_add_u32 s67, s67, s74
    s_waitcnt lgkmcnt(0)
    s_setprio 0
    v_mfma_f32_32x32x16_bf16 v[64:79], v[16:19], v[160:163], 0
    v_exp_f32 v96, v80
    v_exp_f32 v97, v81
    v_cvt_pk_bf16_f32 v55, v110, v111
    v_exp_f32 v98, v82
    v_exp_f32 v99, v83
    v_cvt_pk_bf16_f32 v48, v96, v97
    v_mfma_f32_32x32x16_bf16 v[216:231], v[28:31], v[52:55], v[216:231]
    v_exp_f32 v100, v84
    v_exp_f32 v101, v85
    v_cvt_pk_bf16_f32 v49, v98, v99
    v_exp_f32 v102, v86
    v_exp_f32 v103, v87
    v_cvt_pk_bf16_f32 v50, v100, v101
    v_mfma_f32_32x32x16_bf16 v[64:79], v[20:23], v[164:167], v[64:79]
    v_exp_f32 v104, v88
    v_exp_f32 v105, v89
    v_cvt_pk_bf16_f32 v51, v102, v103
    v_exp_f32 v106, v90
    v_exp_f32 v107, v91
    v_cvt_pk_bf16_f32 v52, v104, v105
    v_mfma_f32_32x32x16_bf16 v[232:247], v[24:27], v[48:51], v[232:247]
    s_add_u32 m0, s52, 15360
    v_exp_f32 v108, v92
    v_exp_f32 v109, v93
    v_cvt_pk_bf16_f32 v53, v106, v107
    buffer_load_dwordx4 v186, s[20:23], s69 offen sc1 lds
    v_exp_f32 v110, v94
    v_exp_f32 v111, v95
    v_cvt_pk_bf16_f32 v54, v108, v109
    s_add_u32 s69, s69, s70
    s_waitcnt vmcnt(6)
    s_barrier
    s_cmp_eq_u32 s64, 8
    s_cbranch_scc1 L_rare_k_27
L_back_k_28:
    s_setprio 3
    v_mfma_f32_32x32x16_bf16 v[80:95], v[16:19], v[168:171], 0
    ds_read_b128 v[16:19], v179 offset:15360
    v_exp_f32 v96, v64
    v_exp_f32 v97, v65
    v_cvt_pk_bf16_f32 v55, v110, v111
    v_exp_f32 v98, v66
    v_exp_f32 v99, v67
    v_cvt_pk_bf16_f32 v48, v96, v97
    v_mfma_f32_32x32x16_bf16 v[232:247], v[28:31], v[52:55], v[232:247]
    s_mov_b64 exec, s[0:1]
    ds_read_b128 v[24:27], v181 offset:10240
    ds_read_b128 v[28:31], v181 offset:10880
    s_mov_b64 exec, -1
    v_exp_f32 v100, v68
    v_exp_f32 v101, v69
    v_cvt_pk_bf16_f32 v49, v98, v99
    v_exp_f32 v102, v70
    v_exp_f32 v103, v71
    v_cvt_pk_bf16_f32 v50, v100, v101
    v_mfma_f32_32x32x16_bf16 v[80:95], v[20:23], v[172:175], v[80:95]
    ds_read_b64 v[20:21], v180 offset:15360
    v_exp_f32 v104, v72
    v_exp_f32 v105, v73
    v_cvt_pk_bf16_f32 v51, v102, v103
    v_exp_f32 v106, v74
    v_exp_f32 v107, v75
    v_cvt_pk_bf16_f32 v52, v104, v105
    s_waitcnt lgkmcnt(2)
    v_mfma_f32_32x32x16_bf16 v[216:231], v[24:27], v[48:51], v[216:231]
    s_add_u32 m0, s68, 20480
    v_exp_f32 v108, v76
    v_exp_f32 v109, v77
    v_cvt_pk_bf16_f32 v53, v106, v107
    buffer_load_dwordx4 v185, s[16:19], s67 offen lds
    v_exp_f32 v110, v78
    v_exp_f32 v111, v79
    v_cvt_pk_bf16_f32 v54, v108, v109
    s_add_u32 s67, s67, s74
    s_waitcnt lgkmcnt(0)
    s_setprio 2
    v_mfma_f32_32x32x16_bf16 v[64:79], v[16:19], v[160:163], 0
    v_exp_f32 v96, v80
    v_exp_f32 v97, v81
    v_cvt_pk_bf16_f32 v55, v110, v111
    v_exp_f32 v98, v82
    v_exp_f32 v99, v83
    v_cvt_pk_bf16_f32 v48, v96, v97
    v_mfma_f32_32x32x16_bf16 v[216:231], v[28:31], v[52:55], v[216:231]
    v_exp_f32 v100, v84
    v_exp_f32 v101, v85
    v_cvt_pk_bf16_f32 v49, v98, v99
    v_exp_f32 v102, v86
    v_exp_f32 v103, v87
    v_cvt_pk_bf16_f32 v50, v100, v101
    v_mfma_f32_32x32x16_bf16 v[64:79], v[20:23], v[164:167], v[64:79]
    v_exp_f32 v104, v88
    v_exp_f32 v105, v89
    v_cvt_pk_bf16_f32 v51, v102, v103
    v_exp_f32 v106, v90
    v_exp_f32 v107, v91
    v_cvt_pk_bf16_f32 v52, v104, v105
    v_mfma_f32_32x32x16_bf16 v[232:247], v[24:27], v[48:51], v[232:247]
    s_add_u32 m0, s53, 0
    v_exp_f32 v108, v92
    v_exp_f32 v109, v93
    v_cvt_pk_bf16_f32 v53, v106, v107
    buffer_load_dwordx4 v186, s[20:23], s69 offen sc1 lds
    v_exp_f32 v110, v94
    v_exp_f32 v111, v95
    v_cvt_pk_bf16_f32 v54, v108, v109
    s_add_u32 s69, s69, s70
    v_add_u32 v179, s36, v179
    v_add_u32 v180, s36, v180
    s_setprio 1
    v_mfma_f32_32x32x16_bf16 v[80:95], v[16:19], v[168:171], 0
    ds_read_b128 v[16:19], v179 offset:0
    v_exp_f32 v96, v64
    v_exp_f32 v97, v65
    v_cvt_pk_bf16_f32 v55, v110, v111
    v_exp_f32 v98, v66
    v_exp_f32 v99, v67
    v_cvt_pk_bf16_f32 v48, v96, v97
    v_mfma_f32_32x32x16_bf16 v[232:247], v[28:31], v[52:55], v[232:247]
    s_mov_b64 exec, s[0:1]
    ds_read_b128 v[24:27], v181 offset:15360
    ds_read_b128 v[28:31], v181 offset:16000
    s_mov_b64 exec, -1
    v_exp_f32 v100, v68
    v_exp_f32 v101, v69
    v_cvt_pk_bf16_f32 v49, v98, v99
    v_exp_f32 v102, v70
    v_exp_f32 v103, v71
    v_cvt_pk_bf16_f32 v50, v100, v101
    v_mfma_f32_32x32x16_bf16 v[80:95], v[20:23], v[172:175], v[80:95]
    ds_read_b64 v[20:21], v180 offset:0
    v_exp_f32 v104, v72
    v_exp_f32 v105, v73
    v_cvt_pk_bf16_f32 v51, v102, v103
    v_exp_f32 v106, v74
    v_exp_f32 v107, v75
    v_cvt_pk_bf16_f32 v52, v104, v105
    s_waitcnt lgkmcnt(2)
    v_mfma_f32_32x32x16_bf16 v[216:231], v[24:27], v[48:51], v[216:231]
    s_add_u32 m0, s68, 30720
    v_exp_f32 v108, v76
    v_exp_f32 v109, v77
    v_cvt_pk_bf16_f32 v53, v106, v107
    buffer_load_dwordx4 v185, s[16:19], s67 offen lds
    v_exp_f32 v110, v78
    v_exp_f32 v111, v79
    v_cvt_pk_bf16_f32 v54, v108, v109
    s_add_u32 s67, s67, s74
    s_waitcnt lgkmcnt(0)
    s_setprio 0
    v_mfma_f32_32x32x16_bf16 v[64:79], v[16:19], v[160:163], 0
    v_exp_f32 v96, v80
    v_exp_f32 v97, v81
    v_cvt_pk_bf16_f32 v55, v110, v111
    v_exp_f32 v98, v82
    v_exp_f32 v99, v83
    v_cvt_pk_bf16_f32 v48, v96, v97
    v_mfma_f32_32x32x16_bf16 v[216:231], v[28:31], v[52:55], v[216:231]
    v_exp_f32 v100, v84
    v_exp_f32 v101, v85
    v_cvt_pk_bf16_f32 v49, v98, v99
    v_exp_f32 v102, v86
    v_exp_f32 v103, v87
    v_cvt_pk_bf16_f32 v50, v100, v101
    v_mfma_f32_32x32x16_bf16 v[64:79], v[20:23], v[164:167], v[64:79]
    v_exp_f32 v104, v88
    v_exp_f32 v105, v89
    v_cvt_pk_bf16_f32 v51, v102, v103
    v_exp_f32 v106, v90
    v_exp_f32 v107, v91
    v_cvt_pk_bf16_f32 v52, v104, v105
    v_mfma_f32_32x32x16_bf16 v[232:247], v[24:27], v[48:51], v[232:247]
    s_add_u32 m0, s53, 5120
    v_exp_f32 v108, v92
    v_exp_f32 v109, v93
    v_cvt_pk_bf16_f32 v53, v106, v107
    buffer_load_dwordx4 v186, s[20:23], s69 offen sc1 lds
    v_exp_f32 v110, v94
    v_exp_f32 v111, v95
    v_cvt_pk_bf16_f32 v54, v108, v109
    s_add_u32 s69, s69, s70
    s_waitcnt vmcnt(6)
    s_barrier
    s_add_u32 s64, s64, 4
    s_mov_b32 s47, s46
    s_add_u32 s46, s46, 40960
    s_cmp_eq_u32 s46, 122880
    s_cselect_b32 s46, 0, s46
    s_add_u32 s68, s33, s46
    s_add_u32 s50, s33, s47
    s_sub_u32 s52, s52, s36
    s_add_u32 s53, s53, s36
    v_add_u32 v181, s36, v181
    s_sub_u32 s36, 0, s36
    s_cmp_lt_u32 s64, 12
    s_cbranch_scc1 L_alphaK
    s_lshl_b32 s61, s74, 1
    s_sub_u32 s67, s67, s61
L_betaK:
    s_setprio 3
    v_mfma_f32_32x32x16_bf16 v[80:95], v[16:19], v[168:171], 0
    ds_read_b128 v[16:19], v179 offset:5120
    buffer_load_dwordx4 v[212:215], v183, s[24:27], s71 offen sc1
    v_exp_f32 v96, v64
    v_exp_f32 v97, v65
    v_cvt_pk_bf16_f32 v55, v110, v111
    s_add_u32 s71, s71, 4096
    ds_read_b64_tr_b16 v[132:133], v184 offset:0
    ds_read_b64_tr_b16 v[134:135], v184 offset:1280
    ds_read_b64_tr_b16 v[136:137], v184 offset:32
    v_exp_f32 v98, v66
    v_exp_f32 v99, v67
    v_cvt_pk_bf16_f32 v48, v96, v97
    v_mfma_f32_32x32x16_bf16 v[232:247], v[28:31], v[52:55], v[232:247]
    s_mov_b64 exec, s[0:1]
    ds_read_b128 v[24:27], v181 offset:0
    ds_read_b128 v[28:31], v181 offset:640
    s_mov_b64 exec, -1
    v_exp_f32 v100, v68
    v_exp_f32 v101, v69
    v_cvt_pk_bf16_f32 v49, v98, v99
    ds_read_b64_tr_b16 v[138:139], v184 offset:1312
    ds_read_b64_tr_b16 v[140:141], v184 offset:64
    ds_read_b64_tr_b16 v[142:143], v184 offset:1344
    v_exp_f32 v102, v70
    v_exp_f32 v103, v71
    v_cvt_pk_bf16_f32 v50, v100, v101
    v_mfma_f32_32x32x16_bf16 v[80:95], v[20:23], v[172:175], v[80:95]
    ds_read_b64 v[20:21], v180 offset:5120
    v_exp_f32 v104, v72
    v_exp_f32 v105, v73
    v_cvt_pk_bf16_f32 v51, v102, v103
    ds_read_b64_tr_b16 v[144:145], v184 offset:96
    ds_read_b64_tr_b16 v[146:147], v184 offset:1376
    ds_read_b64_tr_b16 v[148:149], v184 offset:128
    ds_read_b64_tr_b16 v[150:151], v184 offset:1408
    v_exp_f32 v106, v74
    v_exp_f32 v107, v75
    v_cvt_pk_bf16_f32 v52, v104, v105
    s_waitcnt lgkmcnt(9)
    v_mfma_f32_32x32x16_bf16 v[216:231], v[24:27], v[48:51], v[216:231]
    s_add_u32 m0, s50, 20480
    v_exp_f32 v108, v76
    v_exp_f32 v109, v77
    v_cvt_pk_bf16_f32 v53, v106, v107
    buffer_load_dwordx4 v185, s[16:19], s67 offen lds
    v_exp_f32 v110, v78
    v_exp_f32 v111, v79
    v_cvt_pk_bf16_f32 v54, v108, v109
    s_add_u32 s67, s67, s74
    s_waitcnt lgkmcnt(0)
    s_setprio 2
    v_mfma_f32_32x32x16_bf16 v[64:79], v[16:19], v[160:163], 0
    v_exp_f32 v96, v80
    v_exp_f32 v97, v81
    v_cvt_pk_bf16_f32 v55, v110, v111
    v_mfma_f32_16x16x32_bf16 v[112:115], v[132:135], v[200:203], v[112:115]
    v_exp_f32 v98, v82
    v_exp_f32 v99, v83
    v_cvt_pk_bf16_f32 v48, v96, v97
    v_mfma_f32_32x32x16_bf16 v[216:231], v[28:31], v[52:55], v[216:231]
    v_exp_f32 v100, v84
    v_exp_f32 v101, v85
    v_cvt_pk_bf16_f32 v49, v98, v99
    v_mfma_f32_16x16x32_bf16 v[116:119], v[136:139], v[200:203], v[116:119]
    v_exp_f32 v102, v86
    v_exp_f32 v103, v87
    v_cvt_pk_bf16_f32 v50, v100, v101
    v_mfma_f32_32x32x16_bf16 v[64:79], v[20:23], v[164:167], v[64:79]
    v_exp_f32 v104, v88
    v_exp_f32 v105, v89
    v_cvt_pk_bf16_f32 v51, v102, v103
    v_mfma_f32_16x16x32_bf16 v[120:123], v[140:143], v[200:203], v[120:123]
    v_exp_f32 v106, v90
    v_exp_f32 v107, v91
    v_cvt_pk_bf16_f32 v52, v104, v105
    v_mfma_f32_32x32x16_bf16 v[232:247], v[24:27], v[48:51], v[232:247]
    s_add_u32 m0, s52, 10240
    v_exp_f32 v108, v92
    v_exp_f32 v109, v93
    v_mfma_f32_16x16x32_bf16 v[124:127], v[144:147], v[200:203], v[124:127]
    v_cvt_pk_bf16_f32 v53, v106, v107
    buffer_load_dwordx4 v186, s[20:23], s69 offen sc1 lds
    v_exp_f32 v110, v94
    v_exp_f32 v111, v95
    v_cvt_pk_bf16_f32 v54, v108, v109
    s_add_u32 s69, s69, s70
    v_mfma_f32_16x16x32_bf16 v[128:131], v[148:151], v[200:203], v[128:131]
    s_waitcnt vmcnt(7)
    s_setprio 1
    v_mfma_f32_32x32x16_bf16 v[80:95], v[16:19], v[168:171], 0
    ds_read_b128 v[16:19], v179 offset:10240
    buffer_load_dwordx4 v[200:203], v183, s[24:27], s71 offen sc1
    v_exp_f32 v96, v64
    v_exp_f32 v97, v65
    v_cvt_pk_bf16_f32 v55, v110, v111
    s_add_u32 s71, s71, 4096
    ds_read_b64_tr_b16 v[132:133], v184 offset:10240
    ds_read_b64_tr_b16 v[134:135], v184 offset:11520
    ds_read_b64_tr_b16 v[136:137], v184 offset:10272
    v_exp_f32 v98, v66
    v_exp_f32 v99, v67
    v_cvt_pk_bf16_f32 v48, v96, v97
    v_mfma_f32_32x32x16_bf16 v[232:247], v[28:31], v[52:55], v[232:247]
    s_mov_b64 exec, s[0:1]
    ds_read_b128 v[24:27], v181 offset:5120
    ds_read_b128 v[28:31], v181 offset:5760
    s_mov_b64 exec, -1
    v_exp_f32 v100, v68
    v_exp_f32 v101, v69
    v_cvt_pk_bf16_f32 v49, v98, v99
    ds_read_b64_tr_b16 v[138:139], v184 offset:11552
    ds_read_b64_tr_b16 v[140:141], v184 offset:10304
    ds_read_b64_tr_b16 v[142:143], v184 offset:11584
    v_exp_f32 v102, v70
    v_exp_f32 v103, v71
    v_cvt_pk_bf16_f32 v50, v100, v101
    v_mfma_f32_32x32x16_bf16 v[80:95], v[20:23], v[172:175], v[80:95]
    ds_read_b64 v[20:21], v180 offset:10240
    v_exp_f32 v104, v72
    v_exp_f32 v105, v73
    v_cvt_pk_bf16_f32 v51, v102, v103
    ds_read_b64_tr_b16 v[144:145], v184 offset:10336
    ds_read_b64_tr_b16 v[146:147], v184 offset:11616
    ds_read_b64_tr_b16 v[148:149], v184 offset:10368
    ds_read_b64_tr_b16 v[150:151], v184 offset:11648
    v_exp_f32 v106, v74
    v_exp_f32 v107, v75
    v_cvt_pk_bf16_f32 v52, v104, v105
    s_waitcnt lgkmcnt(9)
    v_mfma_f32_32x32x16_bf16 v[216:231], v[24:27], v[48:51], v[216:231]
    s_add_u32 m0, s50, 30720
    v_exp_f32 v108, v76
    v_exp_f32 v109, v77
    v_cvt_pk_bf16_f32 v53, v106, v107
    buffer_load_dwordx4 v185, s[16:19], s67 offen lds
    v_exp_f32 v110, v78
    v_exp_f32 v111, v79
    v_cvt_pk_bf16_f32 v54, v108, v109
    s_add_u32 s67, s67, s74
    s_waitcnt lgkmcnt(0)
    s_setprio 0
    v_mfma_f32_32x32x16_bf16 v[64:79], v[16:19], v[160:163], 0
    v_exp_f32 v96, v80
    v_exp_f32 v97, v81
    v_cvt_pk_bf16_f32 v55, v110, v111
    v_mfma_f32_16x16x32_bf16 v[112:115], v[132:135], v[204:207], v[112:115]
    v_exp_f32 v98, v82
    v_exp_f32 v99, v83
    v_cvt_pk_bf16_f32 v48, v96, v97
    v_mfma_f32_32x32x16_bf16 v[216:231], v[28:31], v[52:55], v[216:231]
    v_exp_f32 v100, v84
    v_exp_f32 v101, v85
    v_cvt_pk_bf16_f32 v49, v98, v99
    v_mfma_f32_16x16x32_bf16 v[116:119], v[136:139], v[204:207], v[116:119]
    v_exp_f32 v102, v86
    v_exp_f32 v103, v87
    v_cvt_pk_bf16_f32 v50, v100, v101
    v_mfma_f32_32x32x16_bf16 v[64:79], v[20:23], v[164:167], v[64:79]
    v_exp_f32 v104, v88
    v_exp_f32 v105, v89
    v_cvt_pk_bf16_f32 v51, v102, v103
    v_mfma_f32_16x16x32_bf16 v[120:123], v[140:143], v[204:207], v[120:123]
    v_exp_f32 v106, v90
    v_exp_f32 v107, v91
    v_cvt_pk_bf16_f32 v52, v104, v105
    v_mfma_f32_32x32x16_bf16 v[232:247], v[24:27], v[48:51], v[232:247]
    s_add_u32 m0, s52, 15360
    v_exp_f32 v108, v92
    v_exp_f32 v109, v93
    v_mfma_f32_16x16x32_bf16 v[124:127], v[144:147], v[204:207], v[124:127]
    v_cvt_pk_bf16_f32 v53, v106, v107
    buffer_load_dwordx4 v186, s[20:23], s69 offen sc1 lds
    v_exp_f32 v110, v94
    v_exp_f32 v111, v95
    v_cvt_pk_bf16_f32 v54, v108, v109
    s_add_u32 s69, s69, s70
    v_mfma_f32_16x16x32_bf16 v[128:131], v[148:151], v[204:207], v[128:131]
    s_waitcnt vmcnt(7)
    s_barrier
    s_cmp_eq_u32 s64, 24
    s_cbranch_scc1 L_rare_k_29
L_back_k_30:
    s_setprio 3
    v_mfma_f32_32x32x16_bf16 v[80:95], v[16:19], v[168:171], 0
    ds_read_b128 v[16:19], v179 offset:15360
    buffer_load_dwordx4 v[204:207], v183, s[24:27], s71 offen sc1
    v_exp_f32 v96, v64
    v_exp_f32 v97, v65
    v_cvt_pk_bf16_f32 v55, v110, v111
    s_add_u32 s71, s71, 4096
    ds_read_b64_tr_b16 v[132:133], v184 offset:20480
    ds_read_b64_tr_b16 v[134:135], v184 offset:21760
    ds_read_b64_tr_b16 v[136:137], v184 offset:20512
    v_exp_f32 v98, v66
    v_exp_f32 v99, v67
    v_cvt_pk_bf16_f32 v48, v96, v97
    v_mfma_f32_32x32x16_bf16 v[232:247], v[28:31], v[52:55], v[232:247]
    s_mov_b64 exec, s[0:1]
    ds_read_b128 v[24:27], v181 offset:10240
    ds_read_b128 v[28:31], v181 offset:10880
    s_mov_b64 exec, -1
    v_exp_f32 v100, v68
    v_exp_f32 v101, v69
    v_cvt_pk_bf16_f32 v49, v98, v99
    ds_read_b64_tr_b16 v[138:139], v184 offset:21792
    ds_read_b64_tr_b16 v[140:141], v184 offset:20544
    ds_read_b64_tr_b16 v[142:143], v184 offset:21824
    v_exp_f32 v102, v70
    v_exp_f32 v103, v71
    v_cvt_pk_bf16_f32 v50, v100, v101
    v_mfma_f32_32x32x16_bf16 v[80:95], v[20:23], v[172:175], v[80:95]
    ds_read_b64 v[20:21], v180 offset:15360
    v_exp_f32 v104, v72
    v_exp_f32 v105, v73
    v_cvt_pk_bf16_f32 v51, v102, v103
    ds_read_b64_tr_b16 v[144:145], v184 offset:20576
    ds_read_b64_tr_b16 v[146:147], v184 offset:21856
    ds_read_b64_tr_b16 v[148:149], v184 offset:20608
    ds_read_b64_tr_b16 v[150:151], v184 offset:21888
    v_exp_f32 v106, v74
    v_exp_f32 v107, v75
    v_cvt_pk_bf16_f32 v52, v104, v105
    s_waitcnt lgkmcnt(9)
    v_mfma_f32_32x32x16_bf16 v[216:231], v[24:27], v[48:51], v[216:231]
    s_add_u32 m0, s68, 0
    v_exp_f32 v108, v76
    v_exp_f32 v109, v77
    v_cvt_pk_bf16_f32 v53, v106, v107
    buffer_load_dwordx4 v185, s[16:19], s67 offen lds
    v_exp_f32 v110, v78
    v_exp_f32 v111, v79
    v_cvt_pk_bf16_f32 v54, v108, v109
    s_add_u32 s67, s67, s74
    s_waitcnt lgkmcnt(0)
    s_setprio 2
    v_mfma_f32_32x32x16_bf16 v[64:79], v[16:19], v[160:163], 0
    v_exp_f32 v96, v80
    v_exp_f32 v97, v81
    v_cvt_pk_bf16_f32 v55, v110, v111
    v_mfma_f32_16x16x32_bf16 v[112:115], v[132:135], v[208:211], v[112:115]
    v_exp_f32 v98, v82
    v_exp_f32 v99, v83
    v_cvt_pk_bf16_f32 v48, v96, v97
    v_mfma_f32_32x32x16_bf16 v[216:231], v[28:31], v[52:55], v[216:231]
    v_exp_f32 v100, v84
    v_exp_f32 v101, v85
    v_cvt_pk_bf16_f32 v49, v98, v99
    v_mfma_f32_16x16x32_bf16 v[116:119], v[136:139], v[208:211], v[116:119]
    v_exp_f32 v102, v86
    v_exp_f32 v103, v87
    v_cvt_pk_bf16_f32 v50, v100, v101
    v_mfma_f32_32x32x16_bf16 v[64:79], v[20:23], v[164:167], v[64:79]
    v_exp_f32 v104, v88
    v_exp_f32 v105, v89
    v_cvt_pk_bf16_f32 v51, v102, v103
    v_mfma_f32_16x16x32_bf16 v[120:123], v[140:143], v[208:211], v[120:123]
    v_exp_f32 v106, v90
    v_exp_f32 v107, v91
    v_cvt_pk_bf16_f32 v52, v104, v105
    v_mfma_f32_32x32x16_bf16 v[232:247], v[24:27], v[48:51], v[232:247]
    s_add_u32 m0, s53, 0
    v_exp_f32 v108, v92
    v_exp_f32 v109, v93
    v_mfma_f32_16x16x32_bf16 v[124:127], v[144:147], v[208:211], v[124:127]
    v_cvt_pk_bf16_f32 v53, v106, v107
    buffer_load_dwordx4 v186, s[20:23], s69 offen sc1 lds
    v_exp_f32 v110, v94
    v_exp_f32 v111, v95
    v_cvt_pk_bf16_f32 v54, v108, v109
    s_add_u32 s69, s69, s70
    v_mfma_f32_16x16x32_bf16 v[128:131], v[148:151], v[208:211], v[128:131]
    v_add_u32 v179, s36, v179
    v_add_u32 v180, s36, v180
    s_waitcnt vmcnt(7)
    s_setprio 1
    v_mfma_f32_32x32x16_bf16 v[80:95], v[16:19], v[168:171], 0
    ds_read_b128 v[16:19], v179 offset:0
    buffer_load_dwordx4 v[208:211], v183, s[24:27], s71 offen sc1
    v_exp_f32 v96, v64
    v_exp_f32 v97, v65
    v_cvt_pk_bf16_f32 v55, v110, v111
    s_add_u32 s71, s71, 4096
    ds_read_b64_tr_b16 v[132:133], v184 offset:30720
    ds_read_b64_tr_b16 v[134:135], v184 offset:32000
    ds_read_b64_tr_b16 v[136:137], v184 offset:30752
    v_exp_f32 v98, v66
    v_exp_f32 v99, v67
    v_cvt_pk_bf16_f32 v48, v96, v97
    v_mfma_f32_32x32x16_bf16 v[232:247], v[28:31], v[52:55], v[232:247]
    s_mov_b64 exec, s[0:1]
    ds_read_b128 v[24:27], v181 offset:15360
    ds_read_b128 v[28:31], v181 offset:16000
    s_mov_b64 exec, -1
    v_exp_f32 v100, v68
    v_exp_f32 v101, v69
    v_cvt_pk_bf16_f32 v49, v98, v99
    ds_read_b64_tr_b16 v[138:139], v184 offset:32032
    ds_read_b64_tr_b16 v[140:141], v184 offset:30784
    ds_read_b64_tr_b16 v[142:143], v184 offset:32064
    v_exp_f32 v102, v70
    v_exp_f32 v103, v71
    v_cvt_pk_bf16_f32 v50, v100, v101
    v_mfma_f32_32x32x16_bf16 v[80:95], v[20:23], v[172:175], v[80:95]
    ds_read_b64 v[20:21], v180 offset:0
    v_exp_f32 v104, v72
    v_exp_f32 v105, v73
    v_cvt_pk_bf16_f32 v51, v102, v103
    ds_read_b64_tr_b16 v[144:145], v184 offset:30816
    ds_read_b64_tr_b16 v[146:147], v184 offset:32096
    ds_read_b64_tr_b16 v[148:149], v184 offset:30848
    ds_read_b64_tr_b16 v[150:151], v184 offset:32128
    v_exp_f32 v106, v74
    v_exp_f32 v107, v75
    v_cvt_pk_bf16_f32 v52, v104, v105
    s_waitcnt lgkmcnt(9)
    v_mfma_f32_32x32x16_bf16 v[216:231], v[24:27], v[48:51], v[216:231]
    s_add_u32 m0, s68, 10240
    v_exp_f32 v108, v76
    v_exp_f32 v109, v77
    v_cvt_pk_bf16_f32 v53, v106, v107
    buffer_load_dwordx4 v185, s[16:19], s67 offen lds
    v_exp_f32 v110, v78
    v_exp_f32 v111, v79
    v_cvt_pk_bf16_f32 v54, v108, v109
    s_add_u32 s67, s67, s74
    s_waitcnt lgkmcnt(0)
    s_setprio 0
    v_mfma_f32_32x32x16_bf16 v[64:79], v[16:19], v[160:163], 0
    v_exp_f32 v96, v80
    v_exp_f32 v97, v81
    v_cvt_pk_bf16_f32 v55, v110, v111
    v_mfma_f32_16x16x32_bf16 v[112:115], v[132:135], v[212:215], v[112:115]
    v_exp_f32 v98, v82
    v_exp_f32 v99, v83
    v_cvt_pk_bf16_f32 v48, v96, v97
    v_mfma_f32_32x32x16_bf16 v[216:231], v[28:31], v[52:55], v[216:231]
    v_exp_f32 v100, v84
    v_exp_f32 v101, v85
    v_cvt_pk_bf16_f32 v49, v98, v99
    v_mfma_f32_16x16x32_bf16 v[116:119], v[136:139], v[212:215], v[116:119]
    v_exp_f32 v102, v86
    v_exp_f32 v103, v87
    v_cvt_pk_bf16_f32 v50, v100, v101
    v_mfma_f32_32x32x16_bf16 v[64:79], v[20:23], v[164:167], v[64:79]
    v_exp_f32 v104, v88
    v_exp_f32 v105, v89
    v_cvt_pk_bf16_f32 v51, v102, v103
    v_mfma_f32_16x16x32_bf16 v[120:123], v[140:143], v[212:215], v[120:123]
    v_exp_f32 v106, v90
    v_exp_f32 v107, v91
    v_cvt_pk_bf16_f32 v52, v104, v105
    v_mfma_f32_32x32x16_bf16 v[232:247], v[24:27], v[48:51], v[232:247]
    s_add_u32 m0, s53, 5120
    v_exp_f32 v108, v92
    v_exp_f32 v109, v93
    v_mfma_f32_16x16x32_bf16 v[124:127], v[144:147], v[212:215], v[124:127]
    v_cvt_pk_bf16_f32 v53, v106, v107
    buffer_load_dwordx4 v186, s[20:23], s69 offen sc1 lds
    v_exp_f32 v110, v94
    v_exp_f32 v111, v95
    v_cvt_pk_bf16_f32 v54, v108, v109
    s_add_u32 s69, s69, s70
    v_mfma_f32_16x16x32_bf16 v[128:131], v[148:151], v[212:215], v[128:131]
    s_waitcnt vmcnt(7)
    s_barrier
    s_add_u32 s64, s64, 4
    s_mov_b32 s47, s46
    s_add_u32 s46, s46, 40960
    s_cmp_eq_u32 s46, 122880
    s_cselect_b32 s46, 0, s46
    s_add_u32 s68, s33, s46
    s_add_u32 s50, s33, s47
    s_sub_u32 s52, s52, s36
    s_add_u32 s53, s53, s36
    v_add_u32 v181, s36, v181
    s_sub_u32 s36, 0, s36
    s_sub_u32 s54, s46, s47
    v_add_u32 v184, s54, v184
    s_cmp_lt_u32 s64, 32
    s_cbranch_scc1 L_betaK
    s_branch L_p2end
L_p2W:
    s_mov_b32 s68, s33
    s_mov_b32 s50, s33
    s_mov_b32 s52, s66
    s_mov_b32 s53, s66
L_alphaW:
    s_setprio 3
    v_mfma_f32_32x32x16_bf16 v[80:95], v[16:19], v[168:171], 0
    ds_read_b128 v[16:19], v179 offset:5120
    v_exp_f32 v96, v64
    v_exp_f32 v97, v65
    v_cvt_pk_bf16_f32 v55, v110, v111
    v_exp_f32 v98, v66
    v_exp_f32 v99, v67
    v_cvt_pk_bf16_f32 v48, v96, v97
    v_mfma_f32_32x32x16_bf16 v[232:247], v[28:31], v[52:55], v[232:247]
    s_mov_b64 exec, s[0:1]
    ds_read_b128 v[24:27], v181 offset:0
    ds_read_b128 v[28:31], v181 offset:640
    s_mov_b64 exec, -1
    v_exp_f32 v100, v68
    v_exp_f32 v101, v69
    v_cvt_pk_bf16_f32 v49, v98, v99
    v_exp_f32 v102, v70
    v_exp_f32 v103, v71
    v_cvt_pk_bf16_f32 v50, v100, v101
    v_mfma_f32_32x32x16_bf16 v[80:95], v[20:23], v[172:175], v[80:95]
    ds_read_b64 v[20:21], v180 offset:5120
    v_exp_f32 v104, v72
    v_exp_f32 v105, v73
    v_cvt_pk_bf16_f32 v51, v102, v103
    v_exp_f32 v106, v74
    v_exp_f32 v107, v75
    v_cvt_pk_bf16_f32 v52, v104, v105
    s_waitcnt lgkmcnt(2)
    v_mfma_f32_32x32x16_bf16 v[216:231], v[24:27], v[48:51], v[216:231]
    s_add_u32 m0, s68, 0
    v_exp_f32 v108, v76
    v_exp_f32 v109, v77
    v_cvt_pk_bf16_f32 v53, v106, v107
    buffer_load_dwordx4 v185, s[16:19], s67 offen lds
    v_exp_f32 v110, v78
    v_exp_f32 v111, v79
    v_cvt_pk_bf16_f32 v54, v108, v109
    s_add_u32 s67, s67, s74
    s_waitcnt lgkmcnt(0)
    s_setprio 2
    v_mfma_f32_32x32x16_bf16 v[64:79], v[16:19], v[160:163], 0
    v_exp_f32 v96, v80
    v_exp_f32 v97, v81
    v_cvt_pk_bf16_f32 v55, v110, v111
    v_exp_f32 v98, v82
    v_exp_f32 v99, v83
    v_cvt_pk_bf16_f32 v48, v96, v97
    v_mfma_f32_32x32x16_bf16 v[216:231], v[28:31], v[52:55], v[216:231]
    v_exp_f32 v100, v84
    v_exp_f32 v101, v85
    v_cvt_pk_bf16_f32 v49, v98, v99
    v_exp_f32 v102, v86
    v_exp_f32 v103, v87
    v_cvt_pk_bf16_f32 v50, v100, v101
    v_mfma_f32_32x32x16_bf16 v[64:79], v[20:23], v[164:167], v[64:79]
    v_exp_f32 v104, v88
    v_exp_f32 v105, v89
    v_cvt_pk_bf16_f32 v51, v102, v103
    v_exp_f32 v106, v90
    v_exp_f32 v107, v91
    v_cvt_pk_bf16_f32 v52, v104, v105
    v_mfma_f32_32x32x16_bf16 v[232:247], v[24:27], v[48:51], v[232:247]
    s_add_u32 m0, s52, 0
    v_exp_f32 v108, v92
    v_exp_f32 v109, v93
    v_cvt_pk_bf16_f32 v53, v106, v107
    buffer_load_dwordx4 v186, s[20:23], s69 offen sc1 lds
    v_exp_f32 v110, v94
    v_exp_f32 v111, v95
    v_cvt_pk_bf16_f32 v54, v108, v109
    s_add_u32 s69, s69, s70
    s_setprio 1
    v_mfma_f32_32x32x16_bf16 v[80:95], v[16:19], v[168:171], 0
    ds_read_b128 v[16:19], v179 offset:10240
    v_exp_f32 v96, v64
    v_exp_f32 v97, v65
    v_cvt_pk_bf16_f32 v55, v110, v111
    v_exp_f32 v98, v66
    v_exp_f32 v99, v67
    v_cvt_pk_bf16_f32 v48, v96, v97
    v_mfma_f32_32x32x16_bf16 v[232:247], v[28:31], v[52:55], v[232:247]
    s_mov_b64 exec, s[0:1]
    ds_read_b128 v[24:27], v181 offset:5120
    ds_read_b128 v[28:31], v181 offset:5760
    s_mov_b64 exec, -1
    v_exp_f32 v100, v68
    v_exp_f32 v101, v69
    v_cvt_pk_bf16_f32 v49, v98, v99
    v_exp_f32 v102, v70
    v_exp_f32 v103, v71
    v_cvt_pk_bf16_f32 v50, v100, v101
    v_mfma_f32_32x32x16_bf16 v[80:95], v[20:23], v[172:175], v[80:95]
    ds_read_b64 v[20:21], v180 offset:10240
    v_exp_f32 v104, v72
    v_exp_f32 v105, v73
    v_cvt_pk_bf16_f32 v51, v102, v103
    v_exp_f32 v106, v74
    v_exp_f32 v107, v75
    v_cvt_pk_bf16_f32 v52, v104, v105
    s_waitcnt lgkmcnt(2)
    v_mfma_f32_32x32x16_bf16 v[216:231], v[24:27], v[48:51], v[216:231]
    s_add_u32 m0, s68, 10240
    v_exp_f32 v108, v76
    v_exp_f32 v109, v77
    v_cvt_pk_bf16_f32 v53, v106, v107
    buffer_load_dwordx4 v185, s[16:19], s67 offen lds
    v_exp_f32 v110, v78
    v_exp_f32 v111, v79
    v_cvt_pk_bf16_f32 v54, v108, v109
    s_add_u32 s67, s67, s74
    s_waitcnt lgkmcnt(0)
    s_setprio 0
    v_mfma_f32_32x32x16_bf16 v[64:79], v[16:19], v[160:163], 0
    v_exp_f32 v96, v80
    v_exp_f32 v97, v81
    v_cvt_pk_bf16_f32 v55, v110, v111
    v_exp_f32 v98, v82
    v_exp_f32 v99, v83
    v_cvt_pk_bf16_f32 v48, v96, v97
    v_mfma_f32_32x32x16_bf16 v[216:231], v[28:31], v[52:55], v[216:231]
    v_exp_f32 v100, v84
    v_exp_f32 v101, v85
    v_cvt_pk_bf16_f32 v49, v98, v99
    v_exp_f32 v102, v86
    v_exp_f32 v103, v87
    v_cvt_pk_bf16_f32 v50, v100, v101
    v_mfma_f32_32x32x16_bf16 v[64:79], v[20:23], v[164:167], v[64:79]
    v_exp_f32 v104, v88
    v_exp_f32 v105, v89
    v_cvt_pk_bf16_f32 v51, v102, v103
    v_exp_f32 v106, v90
    v_exp_f32 v107, v91
    v_cvt_pk_bf16_f32 v52, v104, v105
    v_mfma_f32_32x32x16_bf16 v[232:247], v[24:27], v[48:51], v[232:247]
    s_add_u32 m0, s52, 10240
    v_exp_f32 v108, v92
    v_exp_f32 v109, v93
    v_cvt_pk_bf16_f32 v53, v106, v107
    buffer_load_dwordx4 v186, s[20:23], s69 offen sc1 lds
    v_exp_f32 v110, v94
    v_exp_f32 v111, v95
    v_cvt_pk_bf16_f32 v54, v108, v109
    s_add_u32 s69, s69, s70
    s_waitcnt vmcnt(6)
    s_cmp_eq_u32 s64, 8
    s_cbranch_scc1 L_rare_k_31
L_back_k_32:
    s_barrier
    s_cmp_eq_u32 s64, 8
    s_cbranch_scc1 L_rare_k_33
L_back_k_34:
    s_cmp_eq_u32 s64, 4
    s_cbranch_scc1 L_rare_k_35
L_back_k_36:
    s_setprio 3
    v_mfma_f32_32x32x16_bf16 v[80:95], v[16:19], v[168:171], 0
    ds_read_b128 v[16:19], v179 offset:15360
    v_exp_f32 v96, v64
    v_exp_f32 v97, v65
    v_cvt_pk_bf16_f32 v55, v110, v111
    v_exp_f32 v98, v66
    v_exp_f32 v99, v67
    v_cvt_pk_bf16_f32 v48, v96, v97
    v_mfma_f32_32x32x16_bf16 v[232:247], v[28:31], v[52:55], v[232:247]
    s_mov_b64 exec, s[0:1]
    ds_read_b128 v[24:27], v181 offset:10240
    ds_read_b128 v[28:31], v181 offset:10880
    s_mov_b64 exec, -1
    v_exp_f32 v100, v68
    v_exp_f32 v101, v69
    v_cvt_pk_bf16_f32 v49, v98, v99
    v_exp_f32 v102, v70
    v_exp_f32 v103, v71
    v_cvt_pk_bf16_f32 v50, v100, v101
    v_mfma_f32_32x32x16_bf16 v[80:95], v[20:23], v[172:175], v[80:95]
    ds_read_b64 v[20:21], v180 offset:15360
    v_exp_f32 v104, v72
    v_exp_f32 v105, v73
    v_cvt_pk_bf16_f32 v51, v102, v103
    v_exp_f32 v106, v74
    v_exp_f32 v107, v75
    v_cvt_pk_bf16_f32 v52, v104, v105
    s_waitcnt lgkmcnt(2)
    v_mfma_f32_32x32x16_bf16 v[216:231], v[24:27], v[48:51], v[216:231]
    s_add_u32 m0, s68, 20480
    v_exp_f32 v108, v76
    v_exp_f32 v109, v77
    v_cvt_pk_bf16_f32 v53, v106, v107
    buffer_load_dwordx4 v185, s[16:19], s67 offen lds
    v_exp_f32 v110, v78
    v_exp_f32 v111, v79
    v_cvt_pk_bf16_f32 v54, v108, v109
    s_add_u32 s67, s67, s74
    s_waitcnt lgkmcnt(0)
    s_setprio 2
    v_mfma_f32_32x32x16_bf16 v[64:79], v[16:19], v[160:163], 0
    v_exp_f32 v96, v80
    v_exp_f32 v97, v81
    v_cvt_pk_bf16_f32 v55, v110, v111
    v_exp_f32 v98, v82
    v_exp_f32 v99, v83
    v_cvt_pk_bf16_f32 v48, v96, v97
    v_mfma_f32_32x32x16_bf16 v[216:231], v[28:31], v[52:55], v[216:231]
    v_exp_f32 v100, v84
    v_exp_f32 v101, v85
    v_cvt_pk_bf16_f32 v49, v98, v99
    v_exp_f32 v102, v86
    v_exp_f32 v103, v87
    v_cvt_pk_bf16_f32 v50, v100, v101
    v_mfma_f32_32x32x16_bf16 v[64:79], v[20:23], v[164:167], v[64:79]
    v_exp_f32 v104, v88
    v_exp_f32 v105, v89
    v_cvt_pk_bf16_f32 v51, v102, v103
    v_exp_f32 v106, v90
    v_exp_f32 v107, v91
    v_cvt_pk_bf16_f32 v52, v104, v105
    v_mfma_f32_32x32x16_bf16 v[232:247], v[24:27], v[48:51], v[232:247]
    s_add_u32 m0, s52, 20480
    v_exp_f32 v108, v92
    v_exp_f32 v109, v93
    v_cvt_pk_bf16_f32 v53, v106, v107
    buffer_load_dwordx4 v186, s[20:23], s69 offen sc1 lds
    v_exp_f32 v110, v94
    v_exp_f32 v111, v95
    v_cvt_pk_bf16_f32 v54, v108, v109
    s_add_u32 s69, s69, s70
    v_add_u32 v179, s36, v179
    v_add_u32 v180, s36, v180
    s_setprio 1
    v_mfma_f32_32x32x16_bf16 v[80:95], v[16:19], v[168:171], 0
    ds_read_b128 v[16:19], v179 offset:0
    v_exp_f32 v96, v64
    v_exp_f32 v97, v65
    v_cvt_pk_bf16_f32 v55, v110, v111
    v_exp_f32 v98, v66
    v_exp_f32 v99, v67
    v_cvt_pk_bf16_f32 v48, v96, v97
    v_mfma_f32_32x32x16_bf16 v[232:247], v[28:31], v[52:55], v[232:247]
    s_mov_b64 exec, s[0:1]
    ds_read_b128 v[24:27], v181 offset:15360
    ds_read_b128 v[28:31], v181 offset:16000
    s_mov_b64 exec, -1
    v_exp_f32 v100, v68
    v_exp_f32 v101, v69
    v_cvt_pk_bf16_f32 v49, v98, v99
    v_exp_f32 v102, v70
    v_exp_f32 v103, v71
    v_cvt_pk_bf16_f32 v50, v100, v101
    v_mfma_f32_32x32x16_bf16 v[80:95], v[20:23], v[172:175], v[80:95]
    ds_read_b64 v[20:21], v180 offset:0
    v_exp_f32 v104, v72
    v_exp_f32 v105, v73
    v_cvt_pk_bf16_f32 v51, v102, v103
    v_exp_f32 v106, v74
    v_exp_f32 v107, v75
    v_cvt_pk_bf16_f32 v52, v104, v105
    s_waitcnt lgkmcnt(2)
    v_mfma_f32_32x32x16_bf16 v[216:231], v[24:27], v[48:51], v[216:231]
    s_add_u32 m0, s68, 30720
    v_exp_f32 v108, v76
    v_exp_f32 v109, v77
    v_cvt_pk_bf16_f32 v53, v106, v107
    buffer_load_dwordx4 v185, s[16:19], s67 offen lds
    v_exp_f32 v110, v78
    v_exp_f32 v111, v79
    v_cvt_pk_bf16_f32 v54, v108, v109
    s_add_u32 s67, s67, s74
    s_waitcnt lgkmcnt(0)
    s_setprio 0
    v_mfma_f32_32x32x16_bf16 v[64:79], v[16:19], v[160:163], 0
    v_exp_f32 v96, v80
    v_exp_f32 v97, v81
    v_cvt_pk_bf16_f32 v55, v110, v111
    v_exp_f32 v98, v82
    v_exp_f32 v99, v83
    v_cvt_pk_bf16_f32 v48, v96, v97
    v_mfma_f32_32x32x16_bf16 v[216:231], v[28:31], v[52:55], v[216:231]
    v_exp_f32 v100, v84
    v_exp_f32 v101, v85
    v_cvt_pk_bf16_f32 v49, v98, v99
    v_exp_f32 v102, v86
    v_exp_f32 v103, v87
    v_cvt_pk_bf16_f32 v50, v100, v101
    v_mfma_f32_32x32x16_bf16 v[64:79], v[20:23], v[164:167], v[64:79]
    v_exp_f32 v104, v88
    v_exp_f32 v105, v89
    v_cvt_pk_bf16_f32 v51, v102, v103
    v_exp_f32 v106, v90
    v_exp_f32 v107, v91
    v_cvt_pk_bf16_f32 v52, v104, v105
    v_mfma_f32_32x32x16_bf16 v[232:247], v[24:27], v[48:51], v[232:247]
    s_add_u32 m0, s52, 30720
    v_exp_f32 v108, v92
    v_exp_f32 v109, v93
    v_cvt_pk_bf16_f32 v53, v106, v107
    buffer_load_dwordx4 v186, s[20:23], s69 offen sc1 lds
    v_exp_f32 v110, v94
    v_exp_f32 v111, v95
    v_cvt_pk_bf16_f32 v54, v108, v109
    s_add_u32 s69, s69, s70
    s_waitcnt vmcnt(6)
    s_barrier
    s_cmp_eq_u32 s64, 0
    s_cbranch_scc1 L_rare_k_37
L_back_k_38:
    s_add_u32 s64, s64, 4
    s_mov_b32 s47, s46
    s_add_u32 s46, s46, 40960
    s_cmp_eq_u32 s46, 122880
    s_cselect_b32 s46, 0, s46
    s_add_u32 s68, s33, s46
    s_add_u32 s50, s33, s47
    s_add_u32 s52, s66, s46
    s_add_u32 s53, s66, s47
    v_add_u32 v181, s36, v181
    s_sub_u32 s36, 0, s36
    s_cmp_lt_u32 s64, 12
    s_cbranch_scc1 L_alphaW
    s_lshl_b32 s61, s74, 1
    s_sub_u32 s67, s67, s61
    s_lshl_b32 s61, s70, 1
    s_sub_u32 s69, s69, s61
L_betaW:
    s_setprio 3
    v_mfma_f32_32x32x16_bf16 v[80:95], v[16:19], v[168:171], 0
    ds_read_b128 v[16:19], v179 offset:5120
    buffer_load_dwordx4 v[212:215], v183, s[24:27], s71 offen sc1
    v_exp_f32 v96, v64
    v_exp_f32 v97, v65
    v_cvt_pk_bf16_f32 v55, v110, v111
    s_add_u32 s71, s71, 4096
    ds_read_b64_tr_b16 v[132:133], v184 offset:0
    ds_read_b64_tr_b16 v[134:135], v184 offset:1280
    ds_read_b64_tr_b16 v[136:137], v184 offset:32
    v_exp_f32 v98, v66
    v_exp_f32 v99, v67
    v_cvt_pk_bf16_f32 v48, v96, v97
    v_mfma_f32_32x32x16_bf16 v[232:247], v[28:31], v[52:55], v[232:247]
    s_mov_b64 exec, s[0:1]
    ds_read_b128 v[24:27], v181 offset:0
    ds_read_b128 v[28:31], v181 offset:640
    s_mov_b64 exec, -1
    v_exp_f32 v100, v68
    v_exp_f32 v101, v69
    v_cvt_pk_bf16_f32 v49, v98, v99
    ds_read_b64_tr_b16 v[138:139], v184 offset:1312
    ds_read_b64_tr_b16 v[140:141], v184 offset:64
    ds_read_b64_tr_b16 v[142:143], v184 offset:1344
    v_exp_f32 v102, v70
    v_exp_f32 v103, v71
    v_cvt_pk_bf16_f32 v50, v100, v101
    v_mfma_f32_32x32x16_bf16 v[80:95], v[20:23], v[172:175], v[80:95]
    ds_read_b64 v[20:21], v180 offset:5120
    v_exp_f32 v104, v72
    v_exp_f32 v105, v73
    v_cvt_pk_bf16_f32 v51, v102, v103
    ds_read_b64_tr_b16 v[144:145], v184 offset:96
    ds_read_b64_tr_b16 v[146:147], v184 offset:1376
    ds_read_b64_tr_b16 v[148:149], v184 offset:128
    ds_read_b64_tr_b16 v[150:151], v184 offset:1408
    v_exp_f32 v106, v74
    v_exp_f32 v107, v75
    v_cvt_pk_bf16_f32 v52, v104, v105
    s_waitcnt lgkmcnt(9)
    v_mfma_f32_32x32x16_bf16 v[216:231], v[24:27], v[48:51], v[216:231]
    s_add_u32 m0, s50, 20480
    v_exp_f32 v108, v76
    v_exp_f32 v109, v77
    v_cvt_pk_bf16_f32 v53, v106, v107
    buffer_load_dwordx4 v185, s[16:19], s67 offen lds
    v_exp_f32 v110, v78
    v_exp_f32 v111, v79
    v_cvt_pk_bf16_f32 v54, v108, v109
    s_add_u32 s67, s67, s74
    s_waitcnt lgkmcnt(0)
    s_setprio 2
    v_mfma_f32_32x32x16_bf16 v[64:79], v[16:19], v[160:163], 0
    v_exp_f32 v96, v80
    v_exp_f32 v97, v81
    v_cvt_pk_bf16_f32 v55, v110, v111
    v_mfma_f32_16x16x32_bf16 v[112:115], v[132:135], v[200:203], v[112:115]
    v_exp_f32 v98, v82
    v_exp_f32 v99, v83
    v_cvt_pk_bf16_f32 v48, v96, v97
    v_mfma_f32_32x32x16_bf16 v[216:231], v[28:31], v[52:55], v[216:231]
    v_exp_f32 v100, v84
    v_exp_f32 v101, v85
    v_cvt_pk_bf16_f32 v49, v98, v99
    v_mfma_f32_16x16x32_bf16 v[116:119], v[136:139], v[200:203], v[116:119]
    v_exp_f32 v102, v86
    v_exp_f32 v103, v87
    v_cvt_pk_bf16_f32 v50, v100, v101
    v_mfma_f32_32x32x16_bf16 v[64:79], v[20:23], v[164:167], v[64:79]
    v_exp_f32 v104, v88
    v_exp_f32 v105, v89
    v_cvt_pk_bf16_f32 v51, v102, v103
    v_mfma_f32_16x16x32_bf16 v[120:123], v[140:143], v[200:203], v[120:123]
    v_exp_f32 v106, v90
    v_exp_f32 v107, v91
    v_cvt_pk_bf16_f32 v52, v104, v105
    v_mfma_f32_32x32x16_bf16 v[232:247], v[24:27], v[48:51], v[232:247]
    s_add_u32 m0, s53, 20480
    v_exp_f32 v108, v92
    v_exp_f32 v109, v93
    v_mfma_f32_16x16x32_bf16 v[124:127], v[144:147], v[200:203], v[124:127]
    v_cvt_pk_bf16_f32 v53, v106, v107
    buffer_load_dwordx4 v186, s[20:23], s69 offen sc1 lds
    v_exp_f32 v110, v94
    v_exp_f32 v111, v95
    v_cvt_pk_bf16_f32 v54, v108, v109
    s_add_u32 s69, s69, s70
    v_mfma_f32_16x16x32_bf16 v[128:131], v[148:151], v[200:203], v[128:131]
    s_waitcnt vmcnt(7)
    s_setprio 1
    v_mfma_f32_32x32x16_bf16 v[80:95], v[16:19], v[168:171], 0
    ds_read_b128 v[16:19], v179 offset:10240
    buffer_load_dwordx4 v[200:203], v183, s[24:27], s71 offen sc1
    v_exp_f32 v96, v64
    v_exp_f32 v97, v65
    v_cvt_pk_bf16_f32 v55, v110, v111
    s_add_u32 s71, s71, 4096
    ds_read_b64_tr_b16 v[132:133], v184 offset:10240
    ds_read_b64_tr_b16 v[134:135], v184 offset:11520
    ds_read_b64_tr_b16 v[136:137], v184 offset:10272
    v_exp_f32 v98, v66
    v_exp_f32 v99, v67
    v_cvt_pk_bf16_f32 v48, v96, v97
    v_mfma_f32_32x32x16_bf16 v[232:247], v[28:31], v[52:55], v[232:247]
    s_mov_b64 exec, s[0:1]
    ds_read_b128 v[24:27], v181 offset:5120
    ds_read_b128 v[28:31], v181 offset:5760
    s_mov_b64 exec, -1
    v_exp_f32 v100, v68
    v_exp_f32 v101, v69
    v_cvt_pk_bf16_f32 v49, v98, v99
    ds_read_b64_tr_b16 v[138:139], v184 offset:11552
    ds_read_b64_tr_b16 v[140:141], v184 offset:10304
    ds_read_b64_tr_b16 v[142:143], v184 offset:11584
    v_exp_f32 v102, v70
    v_exp_f32 v103, v71
    v_cvt_pk_bf16_f32 v50, v100, v101
    v_mfma_f32_32x32x16_bf16 v[80:95], v[20:23], v[172:175], v[80:95]
    ds_read_b64 v[20:21], v180 offset:10240
    v_exp_f32 v104, v72
    v_exp_f32 v105, v73
    v_cvt_pk_bf16_f32 v51, v102, v103
    ds_read_b64_tr_b16 v[144:145], v184 offset:10336
    ds_read_b64_tr_b16 v[146:147], v184 offset:11616
    ds_read_b64_tr_b16 v[148:149], v184 offset:10368
    ds_read_b64_tr_b16 v[150:151], v184 offset:11648
    v_exp_f32 v106, v74
    v_exp_f32 v107, v75
    v_cvt_pk_bf16_f32 v52, v104, v105
    s_waitcnt lgkmcnt(9)
    v_mfma_f32_32x32x16_bf16 v[216:231], v[24:27], v[48:51], v[216:231]
    s_add_u32 m0, s50, 30720
    v_exp_f32 v108, v76
    v_exp_f32 v109, v77
    v_cvt_pk_bf16_f32 v53, v106, v107
    buffer_load_dwordx4 v185, s[16:19], s67 offen lds
    v_exp_f32 v110, v78
    v_exp_f32 v111, v79
    v_cvt_pk_bf16_f32 v54, v108, v109
    s_add_u32 s67, s67, s74
    s_waitcnt lgkmcnt(0)
    s_setprio 0
    v_mfma_f32_32x32x16_bf16 v[64:79], v[16:19], v[160:163], 0
    v_exp_f32 v96, v80
    v_exp_f32 v97, v81
    v_cvt_pk_bf16_f32 v55, v110, v111
    v_mfma_f32_16x16x32_bf16 v[112:115], v[132:135], v[204:207], v[112:115]
    v_exp_f32 v98, v82
    v_exp_f32 v99, v83
    v_cvt_pk_bf16_f32 v48, v96, v97
    v_mfma_f32_32x32x16_bf16 v[216:231], v[28:31], v[52:55], v[216:231]
    v_exp_f32 v100, v84
    v_exp_f32 v101, v85
    v_cvt_pk_bf16_f32 v49, v98, v99
    v_mfma_f32_16x16x32_bf16 v[116:119], v[136:139], v[204:207], v[116:119]
    v_exp_f32 v102, v86
    v_exp_f32 v103, v87
    v_cvt_pk_bf16_f32 v50, v100, v101
    v_mfma_f32_32x32x16_bf16 v[64:79], v[20:23], v[164:167], v[64:79]
    v_exp_f32 v104, v88
    v_exp_f32 v105, v89
    v_cvt_pk_bf16_f32 v51, v102, v103
    v_mfma_f32_16x16x32_bf16 v[120:123], v[140:143], v[204:207], v[120:123]
    v_exp_f32 v106, v90
    v_exp_f32 v107, v91
    v_cvt_pk_bf16_f32 v52, v104, v105
    v_mfma_f32_32x32x16_bf16 v[232:247], v[24:27], v[48:51], v[232:247]
    s_add_u32 m0, s53, 30720
    v_exp_f32 v108, v92
    v_exp_f32 v109, v93
    v_mfma_f32_16x16x32_bf16 v[124:127], v[144:147], v[204:207], v[124:127]
    v_cvt_pk_bf16_f32 v53, v106, v107
    buffer_load_dwordx4 v186, s[20:23], s69 offen sc1 lds
    v_exp_f32 v110, v94
    v_exp_f32 v111, v95
    v_cvt_pk_bf16_f32 v54, v108, v109
    s_add_u32 s69, s69, s70
    v_mfma_f32_16x16x32_bf16 v[128:131], v[148:151], v[204:207], v[128:131]
    s_waitcnt vmcnt(7)
    s_barrier
    s_cmp_eq_u32 s64, 24
    s_cbranch_scc1 L_rare_k_39
L_back_k_40:
    s_setprio 3
    v_mfma_f32_32x32x16_bf16 v[80:95], v[16:19], v[168:171], 0
    ds_read_b128 v[16:19], v179 offset:15360
    buffer_load_dwordx4 v[204:207], v183, s[24:27], s71 offen sc1
    v_exp_f32 v96, v64
    v_exp_f32 v97, v65
    v_cvt_pk_bf16_f32 v55, v110, v111
    s_add_u32 s71, s71, 4096
    ds_read_b64_tr_b16 v[132:133], v184 offset:20480
    ds_read_b64_tr_b16 v[134:135], v184 offset:21760
    ds_read_b64_tr_b16 v[136:137], v184 offset:20512
    v_exp_f32 v98, v66
    v_exp_f32 v99, v67
    v_cvt_pk_bf16_f32 v48, v96, v97
    v_mfma_f32_32x32x16_bf16 v[232:247], v[28:31], v[52:55], v[232:247]
    s_mov_b64 exec, s[0:1]
    ds_read_b128 v[24:27], v181 offset:10240
    ds_read_b128 v[28:31], v181 offset:10880
    s_mov_b64 exec, -1
    v_exp_f32 v100, v68
    v_exp_f32 v101, v69
    v_cvt_pk_bf16_f32 v49, v98, v99
    ds_read_b64_tr_b16 v[138:139], v184 offset:21792
    ds_read_b64_tr_b16 v[140:141], v184 offset:20544
    ds_read_b64_tr_b16 v[142:143], v184 offset:21824
    v_exp_f32 v102, v70
    v_exp_f32 v103, v71
    v_cvt_pk_bf16_f32 v50, v100, v101
    v_mfma_f32_32x32x16_bf16 v[80:95], v[20:23], v[172:175], v[80:95]
    ds_read_b64 v[20:21], v180 offset:15360
    v_exp_f32 v104, v72
    v_exp_f32 v105, v73
    v_cvt_pk_bf16_f32 v51, v102, v103
    ds_read_b64_tr_b16 v[144:145], v184 offset:20576
    ds_read_b64_tr_b16 v[146:147], v184 offset:21856
    ds_read_b64_tr_b16 v[148:149], v184 offset:20608
    ds_read_b64_tr_b16 v[150:151], v184 offset:21888
    v_exp_f32 v106, v74
    v_exp_f32 v107, v75
    v_cvt_pk_bf16_f32 v52, v104, v105
    s_waitcnt lgkmcnt(9)
    v_mfma_f32_32x32x16_bf16 v[216:231], v[24:27], v[48:51], v[216:231]
    s_add_u32 m0, s68, 0
    v_exp_f32 v108, v76
    v_exp_f32 v109, v77
    v_cvt_pk_bf16_f32 v53, v106, v107
    buffer_load_dwordx4 v185, s[16:19], s67 offen lds
    v_exp_f32 v110, v78
    v_exp_f32 v111, v79
    v_cvt_pk_bf16_f32 v54, v108, v109
    s_add_u32 s67, s67, s74
    s_waitcnt lgkmcnt(0)
    s_setprio 2
    v_mfma_f32_32x32x16_bf16 v[64:79], v[16:19], v[160:163], 0
    v_exp_f32 v96, v80
    v_exp_f32 v97, v81
    v_cvt_pk_bf16_f32 v55, v110, v111
    v_mfma_f32_16x16x32_bf16 v[112:115], v[132:135], v[208:211], v[112:115]
    v_exp_f32 v98, v82
    v_exp_f32 v99, v83
    v_cvt_pk_bf16_f32 v48, v96, v97
    v_mfma_f32_32x32x16_bf16 v[216:231], v[28:31], v[52:55], v[216:231]
    v_exp_f32 v100, v84
    v_exp_f32 v101, v85
    v_cvt_pk_bf16_f32 v49, v98, v99
    v_mfma_f32_16x16x32_bf16 v[116:119], v[136:139], v[208:211], v[116:119]
    v_exp_f32 v102, v86
    v_exp_f32 v103, v87
    v_cvt_pk_bf16_f32 v50, v100, v101
    v_mfma_f32_32x32x16_bf16 v[64:79], v[20:23], v[164:167], v[64:79]
    v_exp_f32 v104, v88
    v_exp_f32 v105, v89
    v_cvt_pk_bf16_f32 v51, v102, v103
    v_mfma_f32_16x16x32_bf16 v[120:123], v[140:143], v[208:211], v[120:123]
    v_exp_f32 v106, v90
    v_exp_f32 v107, v91
    v_cvt_pk_bf16_f32 v52, v104, v105
    v_mfma_f32_32x32x16_bf16 v[232:247], v[24:27], v[48:51], v[232:247]
    s_add_u32 m0, s52, 0
    v_exp_f32 v108, v92
    v_exp_f32 v109, v93
    v_mfma_f32_16x16x32_bf16 v[124:127], v[144:147], v[208:211], v[124:127]
    v_cvt_pk_bf16_f32 v53, v106, v107
    buffer_load_dwordx4 v186, s[20:23], s69 offen sc1 lds
    v_exp_f32 v110, v94
    v_exp_f32 v111, v95
    v_cvt_pk_bf16_f32 v54, v108, v109
    s_add_u32 s69, s69, s70
    v_mfma_f32_16x16x32_bf16 v[128:131], v[148:151], v[208:211], v[128:131]
    v_add_u32 v179, s36, v179
    v_add_u32 v180, s36, v180
    s_waitcnt vmcnt(7)
    s_setprio 1
    v_mfma_f32_32x32x16_bf16 v[80:95], v[16:19], v[168:171], 0
    ds_read_b128 v[16:19], v179 offset:0
    buffer_load_dwordx4 v[208:211], v183, s[24:27], s71 offen sc1
    v_exp_f32 v96, v64
    v_exp_f32 v97, v65
    v_cvt_pk_bf16_f32 v55, v110, v111
    s_add_u32 s71, s71, 4096
    ds_read_b64_tr_b16 v[132:133], v184 offset:30720
    ds_read_b64_tr_b16 v[134:135], v184 offset:32000
    ds_read_b64_tr_b16 v[136:137], v184 offset:30752
    v_exp_f32 v98, v66
    v_exp_f32 v99, v67
    v_cvt_pk_bf16_f32 v48, v96, v97
    v_mfma_f32_32x32x16_bf16 v[232:247], v[28:31], v[52:55], v[232:247]
    s_mov_b64 exec, s[0:1]
    ds_read_b128 v[24:27], v181 offset:15360
    ds_read_b128 v[28:31], v181 offset:16000
    s_mov_b64 exec, -1
    v_exp_f32 v100, v68
    v_exp_f32 v101, v69
    v_cvt_pk_bf16_f32 v49, v98, v99
    ds_read_b64_tr_b16 v[138:139], v184 offset:32032
    ds_read_b64_tr_b16 v[140:141], v184 offset:30784
    ds_read_b64_tr_b16 v[142:143], v184 offset:32064
    v_exp_f32 v102, v70
    v_exp_f32 v103, v71
    v_cvt_pk_bf16_f32 v50, v100, v101
    v_mfma_f32_32x32x16_bf16 v[80:95], v[20:23], v[172:175], v[80:95]
    ds_read_b64 v[20:21], v180 offset:0
    v_exp_f32 v104, v72
    v_exp_f32 v105, v73
    v_cvt_pk_bf16_f32 v51, v102, v103
    ds_read_b64_tr_b16 v[144:145], v184 offset:30816
    ds_read_b64_tr_b16 v[146:147], v184 offset:32096
    ds_read_b64_tr_b16 v[148:149], v184 offset:30848
    ds_read_b64_tr_b16 v[150:151], v184 offset:32128
    v_exp_f32 v106, v74
    v_exp_f32 v107, v75
    v_cvt_pk_bf16_f32 v52, v104, v105
    s_waitcnt lgkmcnt(9)
    v_mfma_f32_32x32x16_bf16 v[216:231], v[24:27], v[48:51], v[216:231]
    s_add_u32 m0, s68, 10240
    v_exp_f32 v108, v76
    v_exp_f32 v109, v77
    v_cvt_pk_bf16_f32 v53, v106, v107
    buffer_load_dwordx4 v185, s[16:19], s67 offen lds
    v_exp_f32 v110, v78
    v_exp_f32 v111, v79
    v_cvt_pk_bf16_f32 v54, v108, v109
    s_add_u32 s67, s67, s74
    s_waitcnt lgkmcnt(0)
    s_setprio 0
    v_mfma_f32_32x32x16_bf16 v[64:79], v[16:19], v[160:163], 0
    v_exp_f32 v96, v80
    v_exp_f32 v97, v81
    v_cvt_pk_bf16_f32 v55, v110, v111
    v_mfma_f32_16x16x32_bf16 v[112:115], v[132:135], v[212:215], v[112:115]
    v_exp_f32 v98, v82
    v_exp_f32 v99, v83
    v_cvt_pk_bf16_f32 v48, v96, v97
    v_mfma_f32_32x32x16_bf16 v[216:231], v[28:31], v[52:55], v[216:231]
    v_exp_f32 v100, v84
    v_exp_f32 v101, v85
    v_cvt_pk_bf16_f32 v49, v98, v99
    v_mfma_f32_16x16x32_bf16 v[116:119], v[136:139], v[212:215], v[116:119]
    v_exp_f32 v102, v86
    v_exp_f32 v103, v87
    v_cvt_pk_bf16_f32 v50, v100, v101
    v_mfma_f32_32x32x16_bf16 v[64:79], v[20:23], v[164:167], v[64:79]
    v_exp_f32 v104, v88
    v_exp_f32 v105, v89
    v_cvt_pk_bf16_f32 v51, v102, v103
    v_mfma_f32_16x16x32_bf16 v[120:123], v[140:143], v[212:215], v[120:123]
    v_exp_f32 v106, v90
    v_exp_f32 v107, v91
    v_cvt_pk_bf16_f32 v52, v104, v105
    v_mfma_f32_32x32x16_bf16 v[232:247], v[24:27], v[48:51], v[232:247]
    s_add_u32 m0, s52, 10240
    v_exp_f32 v108, v92
    v_exp_f32 v109, v93
    v_mfma_f32_16x16x32_bf16 v[124:127], v[144:147], v[212:215], v[124:127]
    v_cvt_pk_bf16_f32 v53, v106, v107
    buffer_load_dwordx4 v186, s[20:23], s69 offen sc1 lds
    v_exp_f32 v110, v94
    v_exp_f32 v111, v95
    v_cvt_pk_bf16_f32 v54, v108, v109
    s_add_u32 s69, s69, s70
    v_mfma_f32_16x16x32_bf16 v[128:131], v[148:151], v[212:215], v[128:131]
    s_waitcnt vmcnt(7)
    s_barrier
    s_add_u32 s64, s64, 4
    s_mov_b32 s47, s46
    s_add_u32 s46, s46, 40960
    s_cmp_eq_u32 s46, 122880
    s_cselect_b32 s46, 0, s46
    s_add_u32 s68, s33, s46
    s_add_u32 s50, s33, s47
    s_add_u32 s52, s66, s46
    s_add_u32 s53, s66, s47
    v_add_u32 v181, s36, v181
    s_sub_u32 s36, 0, s36
    s_sub_u32 s54, s46, s47
    v_add_u32 v184, s54, v184
    s_cmp_lt_u32 s64, 32
    s_cbranch_scc1 L_betaW
L_p2end:
    s_setprio 0
    v_cvt_pk_bf16_f32 v55, v110, v111
    buffer_load_dwordx4 v[212:215], v183, s[24:27], s71 offen sc1
    s_nop 0
    v_mfma_f32_32x32x16_bf16 v[232:247], v[28:31], v[52:55], v[232:247]
    s_nop 7
    s_nop 7
    s_mul_i32 s61, s3, 3072
    s_add_u32 s61, s61, 133120
    v_add_u32 v2, s61, v177
    s_cmp_eq_u32 s59, 0
    s_cbranch_scc1 L_x0
    ds_write_b128 v2, v[216:219] offset:0
    ds_write_b128 v2, v[220:223] offset:1024
    ds_write_b128 v2, v[224:227] offset:2048
    s_waitcnt lgkmcnt(0)
    v_mov_b32 v216, v232
    v_mov_b32 v217, v233
    v_mov_b32 v218, v234
    v_mov_b32 v219, v235
    v_mov_b32 v220, v236
    v_mov_b32 v221, v237
    v_mov_b32 v222, v238
    v_mov_b32 v223, v239
    v_mov_b32 v224, v240
    v_mov_b32 v225, v241
    v_mov_b32 v226, v242
    v_mov_b32 v227, v243
    s_branch L_x1
L_x0:
    ds_write_b128 v2, v[232:235] offset:0
    ds_write_b128 v2, v[236:239] offset:1024
    ds_write_b128 v2, v[240:243] offset:2048
    s_waitcnt lgkmcnt(0)
L_x1:
    s_barrier
    s_xor_b32 s61, s3, 4
    s_mul_i32 s61, s61, 3072
    s_add_u32 s61, s61, 133120
    v_add_u32 v2, s61, v177
    ds_read_b128 v[64:67], v2 offset:0
    ds_read_b128 v[68:71], v2 offset:1024
    ds_read_b128 v[72:75], v2 offset:2048
    s_waitcnt lgkmcnt(0)
    s_mov_b64 s[100:101], -1
    v_add_f32 v216, v216, v64
    v_add_f32 v217, v217, v65
    v_add_f32 v218, v218, v66
    v_add_f32 v219, v219, v67
    v_add_f32 v220, v220, v68
    v_add_f32 v221, v221, v69
    v_add_f32 v222, v222, v70
    v_add_f32 v223, v223, v71
    v_add_f32 v224, v224, v72
    v_add_f32 v225, v225, v73
    v_add_f32 v226, v226, v74
    v_add_f32 v227, v227, v75
L_norm:
    v_mov_b32 v80, v224
    v_mov_b32 v81, v224
    v_mov_b32 v82, 0
    s_nop 1
    v_permlane32_swap_b32 v80, v81
    v_fma_f32 v82, v216, 0, v82
    v_fma_f32 v82, v217, 0, v82
    v_fma_f32 v82, v218, 0, v82
    v_fma_f32 v82, v219, 0, v82
    v_fma_f32 v82, v220, 0, v82
    v_fma_f32 v82, v221, 0, v82
    v_fma_f32 v82, v222, 0, v82
    v_fma_f32 v82, v223, 0, v82
    v_fma_f32 v82, v224, 0, v82
    v_fma_f32 v82, v225, 0, v82
    v_fma_f32 v82, v226, 0, v82
    v_fma_f32 v82, v227, 0, v82
    s_mov_b32 s61, 0x17800000
    s_mov_b32 s62, 0x71800000
    v_add_f32 v82, v82, v81
    v_cmp_nle_f32 vcc, s61, v82
    v_mov_b32 v83, 0x71800000
    v_cmp_nle_f32 s[62:63], v82, v83
    s_or_b64 vcc, vcc, s[62:63]
    s_and_b64 vcc, vcc, s[100:101]
    s_cmp_lg_u64 vcc, 0
    s_cbranch_scc1 L_fallback
    v_rcp_f32 v81, v81
    s_nop 0
    v_mul_f32 v81, v81, v176
    v_mul_f32 v216, v81, v216
    v_mul_f32 v217, v81, v217
    v_mul_f32 v218, v81, v218
    v_mul_f32 v219, v81, v219
    v_mul_f32 v220, v81, v220
    v_mul_f32 v221, v81, v221
    v_mul_f32 v222, v81, v222
    v_mul_f32 v223, v81, v223
    v_mul_f32 v224, v81, v224
    v_mul_f32 v225, v81, v225
    v_mul_f32 v226, v81, v226
    v_mul_f32 v227, v81, v227
    v_cvt_pk_bf16_f32 v84, v216, v217
    v_cvt_pk_bf16_f32 v85, v218, v219
    v_cvt_pk_bf16_f32 v86, v220, v221
    v_cvt_pk_bf16_f32 v87, v222, v223
    v_cvt_pk_bf16_f32 v88, v224, v225
    v_cvt_pk_bf16_f32 v89, v226, v227
    s_add_u32 s61, s49, s59
    s_mul_i32 s62, s61, 40
    s_add_u32 s63, s62, s48
    s_lshl_b32 s63, s63, 10
    s_add_u32 s63, s63, 14155776
    buffer_store_dwordx4 v[84:87], v177, s[24:27], s63 offen sc1
    s_lshl_b32 s63, s62, 10
    s_lshl_b32 s62, s48, 8
    s_add_u32 s63, s63, s62
    s_add_u32 s63, s63, 14188544
    s_mov_b32 exec_hi, 0
    buffer_store_dwordx2 v[88:89], v178, s[24:27], s63 offen sc1
    s_mov_b32 exec_hi, -1
    s_lshl_b32 s35, s61, 5
    s_add_u32 s35, s35, s48
    s_lshl_b32 s35, s35, 2
    s_add_u32 s35, s35, 16787456
    s_add_u32 m0, s33, 61440
    s_nop 0
    buffer_load_dwordx4 v185, s[16:19], s67 offen lds
    s_add_u32 s67, s67, s74
    s_add_u32 m0, s33, 71680
    s_nop 0
    buffer_load_dwordx4 v185, s[16:19], s67 offen lds
    s_add_u32 s67, s67, s74
    v_mov_b32 v2, s60
    v_mov_b32 v3, 0
    s_cmp_eq_u32 s38, 0
    s_cbranch_scc1 L_w31_k_41
    s_add_u32 m0, s66, 61440
    s_nop 0
    buffer_load_dwordx4 v186, s[20:23], s69 offen lds
    s_add_u32 s69, s69, s70
    s_add_u32 m0, s66, 71680
    s_nop 0
    buffer_load_dwordx4 v186, s[20:23], s69 offen lds
    s_add_u32 s69, s69, s70
    s_waitcnt vmcnt(6)
    s_branch L_w32_k_42
L_w31_k_41:
    s_waitcnt vmcnt(4)
L_w32_k_42:
    ds_read_b64_tr_b16 v[132:133], v194 offset:20480
    ds_read_b64_tr_b16 v[134:135], v194 offset:21760
    ds_read_b64_tr_b16 v[136:137], v194 offset:20512
    ds_read_b64_tr_b16 v[138:139], v194 offset:21792
    ds_read_b64_tr_b16 v[140:141], v194 offset:20544
    ds_read_b64_tr_b16 v[142:143], v194 offset:21824
    ds_read_b64_tr_b16 v[144:145], v194 offset:20576
    ds_read_b64_tr_b16 v[146:147], v194 offset:21856
    ds_read_b64_tr_b16 v[148:149], v194 offset:20608
    ds_read_b64_tr_b16 v[150:151], v194 offset:21888
    ds_read_b64_tr_b16 v[16:17], v194 offset:30720
    ds_read_b64_tr_b16 v[18:19], v194 offset:32000
    ds_read_b64_tr_b16 v[20:21], v194 offset:30752
    ds_read_b64_tr_b16 v[22:23], v194 offset:32032
    ds_read_b64_tr_b16 v[24:25], v194 offset:30784
    ds_read_b64_tr_b16 v[26:27], v194 offset:32064
    ds_read_b64_tr_b16 v[28:29], v194 offset:30816
    ds_read_b64_tr_b16 v[30:31], v194 offset:32096
    ds_read_b64_tr_b16 v[32:33], v194 offset:30848
    ds_read_b64_tr_b16 v[34:35], v194 offset:32128
    s_waitcnt lgkmcnt(10)
    v_mfma_f32_16x16x32_bf16 v[112:115], v[132:135], v[200:203], v[112:115]
    v_mfma_f32_16x16x32_bf16 v[116:119], v[136:139], v[200:203], v[116:119]
    v_mfma_f32_16x16x32_bf16 v[120:123], v[140:143], v[200:203], v[120:123]
    v_mfma_f32_16x16x32_bf16 v[124:127], v[144:147], v[200:203], v[124:127]
    v_mfma_f32_16x16x32_bf16 v[128:131], v[148:151], v[200:203], v[128:131]
    ds_read_b64_tr_b16 v[132:133], v194 offset:40960
    ds_read_b64_tr_b16 v[134:135], v194 offset:42240
    ds_read_b64_tr_b16 v[136:137], v194 offset:40992
    ds_read_b64_tr_b16 v[138:139], v194 offset:42272
    ds_read_b64_tr_b16 v[140:141], v194 offset:41024
    ds_read_b64_tr_b16 v[142:143], v194 offset:42304
    ds_read_b64_tr_b16 v[144:145], v194 offset:41056
    ds_read_b64_tr_b16 v[146:147], v194 offset:42336
    ds_read_b64_tr_b16 v[148:149], v194 offset:41088
    ds_read_b64_tr_b16 v[150:151], v194 offset:42368
    s_waitcnt lgkmcnt(10)
    v_mfma_f32_16x16x32_bf16 v[112:115], v[16:19], v[204:207], v[112:115]
    v_mfma_f32_16x16x32_bf16 v[116:119], v[20:23], v[204:207], v[116:119]
    v_mfma_f32_16x16x32_bf16 v[120:123], v[24:27], v[204:207], v[120:123]
    v_mfma_f32_16x16x32_bf16 v[124:127], v[28:31], v[204:207], v[124:127]
    v_mfma_f32_16x16x32_bf16 v[128:131], v[32:35], v[204:207], v[128:131]
    ds_read_b64_tr_b16 v[16:17], v194 offset:51200
    ds_read_b64_tr_b16 v[18:19], v194 offset:52480
    ds_read_b64_tr_b16 v[20:21], v194 offset:51232
    ds_read_b64_tr_b16 v[22:23], v194 offset:52512
    ds_read_b64_tr_b16 v[24:25], v194 offset:51264
    ds_read_b64_tr_b16 v[26:27], v194 offset:52544
    ds_read_b64_tr_b16 v[28:29], v194 offset:51296
    ds_read_b64_tr_b16 v[30:31], v194 offset:52576
    ds_read_b64_tr_b16 v[32:33], v194 offset:51328
    ds_read_b64_tr_b16 v[34:35], v194 offset:52608
    s_waitcnt lgkmcnt(10)
    v_mfma_f32_16x16x32_bf16 v[112:115], v[132:135], v[208:211], v[112:115]
    v_mfma_f32_16x16x32_bf16 v[116:119], v[136:139], v[208:211], v[116:119]
    v_mfma_f32_16x16x32_bf16 v[120:123], v[140:143], v[208:211], v[120:123]
    v_mfma_f32_16x16x32_bf16 v[124:127], v[144:147], v[208:211], v[124:127]
    v_mfma_f32_16x16x32_bf16 v[128:131], v[148:151], v[208:211], v[128:131]
    s_waitcnt lgkmcnt(0)
    v_mfma_f32_16x16x32_bf16 v[112:115], v[16:19], v[212:215], v[112:115]
    v_mfma_f32_16x16x32_bf16 v[116:119], v[20:23], v[212:215], v[116:119]
    v_mfma_f32_16x16x32_bf16 v[120:123], v[24:27], v[212:215], v[120:123]
    v_mfma_f32_16x16x32_bf16 v[124:127], v[28:31], v[212:215], v[124:127]
    v_mfma_f32_16x16x32_bf16 v[128:131], v[32:35], v[212:215], v[128:131]
    s_cmp_eq_u32 s38, 0
    s_cbranch_scc1 L_w33_k_43
    s_waitcnt vmcnt(4)
    s_branch L_w34_k_44
L_w33_k_43:
    s_waitcnt vmcnt(2)
L_w34_k_44:
    s_mov_b64 exec, 1
    buffer_store_dword v2, v3, s[24:27], s35 offen sc1
    s_mov_b64 exec, -1
    s_waitcnt vmcnt(1)
    v_sub_f32 v56, 1.0, v187
    s_nop 7
    v_mul_f32 v112, v56, v112
    v_mul_f32 v113, v56, v113
    v_mul_f32 v114, v56, v114
    v_mul_f32 v115, v56, v115
    v_mul_f32 v116, v56, v116
    v_mul_f32 v117, v56, v117
    v_mul_f32 v118, v56, v118
    v_mul_f32 v119, v56, v119
    v_mul_f32 v120, v56, v120
    v_mul_f32 v121, v56, v121
    v_mul_f32 v122, v56, v122
    v_mul_f32 v123, v56, v123
    v_mul_f32 v124, v56, v124
    v_mul_f32 v125, v56, v125
    v_mul_f32 v126, v56, v126
    v_mul_f32 v127, v56, v127
    v_mul_f32 v128, v56, v128
    v_mul_f32 v129, v56, v129
    v_mul_f32 v130, v56, v130
    v_mul_f32 v131, v56, v131
    s_barrier
    s_mul_i32 s61, s73, 204800
    s_add_u32 s61, s61, 0
    s_add_u32 s61, s61, s72
    s_add_u32 m0, s33, 81920
    s_nop 0
    buffer_load_dwordx4 v190, s[8:11], s61 offen lds
    s_mul_i32 s61, s73, 204800
    s_add_u32 s61, s61, 409600
    s_add_u32 s61, s61, s72
    s_add_u32 m0, s33, 92160
    s_nop 0
    buffer_load_dwordx4 v190, s[8:11], s61 offen lds
    s_cmp_eq_u32 s38, 0
    s_cbranch_scc1 L_rb_k_45
    s_add_u32 s61, s72, 204800
    s_add_u32 m0, s66, 81920
    s_nop 0
    buffer_load_dwordx4 v191, s[8:11], s61 offen lds
    s_add_u32 s61, s72, 614400
    s_add_u32 m0, s66, 92160
    s_nop 0
    buffer_load_dwordx4 v191, s[8:11], s61 offen lds
L_rb_k_45:
    s_cmp_eq_u32 s3, 0
    s_cbranch_scc0 L_f3_k_46
    v_lshlrev_b32 v2, 2, v1
    s_lshl_b32 s63, s44, 8
    s_add_u32 s63, s63, 16787456
    s_mov_b32 s75, 0
    s_waitcnt vmcnt(0)
    buffer_load_dword v3, v2, s[24:27], s63 offen sc1
    s_sleep 3
    buffer_load_dword v56, v2, s[24:27], s63 offen sc1
    s_sleep 3
L_f3p_k_47:
    buffer_load_dword v57, v2, s[24:27], s63 offen sc1
    s_waitcnt vmcnt(2)
    v_cmp_ne_u32 vcc, s60, v3
    s_nop 0
    s_cmp_eq_u64 vcc, 0
    s_cbranch_scc1 L_f3d_k_48
    buffer_load_dword v3, v2, s[24:27], s63 offen sc1
    s_waitcnt vmcnt(2)
    v_cmp_ne_u32 vcc, s60, v56
    s_nop 0
    s_cmp_eq_u64 vcc, 0
    s_cbranch_scc1 L_f3d_k_48
    buffer_load_dword v56, v2, s[24:27], s63 offen sc1
    s_waitcnt vmcnt(2)
    v_cmp_ne_u32 vcc, s60, v57
    s_nop 0
    s_cmp_eq_u64 vcc, 0
    s_cbranch_scc1 L_f3d_k_48
    s_add_u32 s75, s75, 1
    s_cmp_lt_u32 s75, 131072
    s_cbranch_scc1 L_f3p_k_47
L_f3d_k_48:
L_f3_k_46:
    s_barrier
    s_mul_i32 s61, s32, 40960
    s_add_u32 s61, s61, 14155776
    s_add_u32 s63, s61, 32768
    s_lshl_b32 s62, s59, 11
    s_add_u32 s61, s61, s62
    s_add_u32 s63, s63, s62
    buffer_load_dwordx4 v[64:67], v182, s[24:27], s61 offen sc1
    s_add_u32 s61, s61, 4096
    buffer_load_dwordx4 v[68:71], v182, s[24:27], s61 offen sc1
    s_add_u32 s61, s61, 4096
    buffer_load_dwordx4 v[72:75], v182, s[24:27], s61 offen sc1
    s_add_u32 s61, s61, 4096
    buffer_load_dwordx4 v[76:79], v182, s[24:27], s61 offen sc1
    s_add_u32 s61, s61, 4096
    buffer_load_dwordx4 v[80:83], v182, s[24:27], s61 offen sc1
    s_add_u32 s61, s61, 4096
    buffer_load_dwordx4 v[84:87], v182, s[24:27], s61 offen sc1
    s_add_u32 s61, s61, 4096
    buffer_load_dwordx4 v[88:91], v182, s[24:27], s61 offen sc1
    s_add_u32 s61, s61, 4096
    buffer_load_dwordx4 v[92:95], v182, s[24:27], s61 offen sc1
    s_add_u32 s61, s61, 4096
    v_lshrrev_b32 v58, 4, v1
    v_lshlrev_b32 v58, 9, v58
    v_and_b32 v59, 15, v1
    s_and_b32 s62, s58, 1
    s_lshl_b32 s62, s62, 7
    v_lshl_add_u32 v58, v59, 3, v58
    v_add_u32 v58, s62, v58
    buffer_load_dwordx2 v[96:97], v58, s[24:27], s63 offen sc1
    buffer_load_dwordx2 v[98:99], v58, s[24:27], s63 offen offset:256 sc1
    s_add_u32 s63, s63, 4096
    buffer_load_dwordx2 v[100:101], v58, s[24:27], s63 offen sc1
    buffer_load_dwordx2 v[102:103], v58, s[24:27], s63 offen offset:256 sc1
    s_add_u32 s63, s63, 4096
    ds_read_b64_tr_b16 v[132:133], v193 offset:0
    ds_read_b64_tr_b16 v[134:135], v193 offset:1280
    ds_read_b64_tr_b16 v[136:137], v193 offset:32
    ds_read_b64_tr_b16 v[138:139], v193 offset:1312
    ds_read_b64_tr_b16 v[140:141], v193 offset:64
    ds_read_b64_tr_b16 v[142:143], v193 offset:1344
    ds_read_b64_tr_b16 v[144:145], v193 offset:96
    ds_read_b64_tr_b16 v[146:147], v193 offset:1376
    ds_read_b64_tr_b16 v[148:149], v193 offset:128
    ds_read_b64_tr_b16 v[150:151], v193 offset:1408
    ds_read_b64_tr_b16 v[16:17], v193 offset:10240
    ds_read_b64_tr_b16 v[18:19], v193 offset:11520
    ds_read_b64_tr_b16 v[20:21], v193 offset:10272
    ds_read_b64_tr_b16 v[22:23], v193 offset:11552
    ds_read_b64_tr_b16 v[24:25], v193 offset:10304
    ds_read_b64_tr_b16 v[26:27], v193 offset:11584
    ds_read_b64_tr_b16 v[28:29], v193 offset:10336
    ds_read_b64_tr_b16 v[30:31], v193 offset:11616
    ds_read_b64_tr_b16 v[32:33], v193 offset:10368
    ds_read_b64_tr_b16 v[34:35], v193 offset:11648
    s_waitcnt lgkmcnt(10)
    s_waitcnt vmcnt(11)
    v_mfma_f32_16x16x32_bf16 v[112:115], v[132:135], v[64:67], v[112:115]
    v_mfma_f32_16x16x32_bf16 v[116:119], v[136:139], v[64:67], v[116:119]
    v_mfma_f32_16x16x32_bf16 v[120:123], v[140:143], v[64:67], v[120:123]
    v_mfma_f32_16x16x32_bf16 v[124:127], v[144:147], v[64:67], v[124:127]
    v_mfma_f32_16x16x32_bf16 v[128:131], v[148:151], v[64:67], v[128:131]
    ds_read_b64_tr_b16 v[132:133], v193 offset:20480
    ds_read_b64_tr_b16 v[134:135], v193 offset:21760
    ds_read_b64_tr_b16 v[136:137], v193 offset:20512
    ds_read_b64_tr_b16 v[138:139], v193 offset:21792
    ds_read_b64_tr_b16 v[140:141], v193 offset:20544
    ds_read_b64_tr_b16 v[142:143], v193 offset:21824
    ds_read_b64_tr_b16 v[144:145], v193 offset:20576
    ds_read_b64_tr_b16 v[146:147], v193 offset:21856
    ds_read_b64_tr_b16 v[148:149], v193 offset:20608
    ds_read_b64_tr_b16 v[150:151], v193 offset:21888
    s_waitcnt lgkmcnt(10)
    s_waitcnt vmcnt(10)
    v_mfma_f32_16x16x32_bf16 v[112:115], v[16:19], v[68:71], v[112:115]
    v_mfma_f32_16x16x32_bf16 v[116:119], v[20:23], v[68:71], v[116:119]
    v_mfma_f32_16x16x32_bf16 v[120:123], v[24:27], v[68:71], v[120:123]
    v_mfma_f32_16x16x32_bf16 v[124:127], v[28:31], v[68:71], v[124:127]
    v_mfma_f32_16x16x32_bf16 v[128:131], v[32:35], v[68:71], v[128:131]
    ds_read_b64_tr_b16 v[16:17], v193 offset:30720
    ds_read_b64_tr_b16 v[18:19], v193 offset:32000
    ds_read_b64_tr_b16 v[20:21], v193 offset:30752
    ds_read_b64_tr_b16 v[22:23], v193 offset:32032
    ds_read_b64_tr_b16 v[24:25], v193 offset:30784
    ds_read_b64_tr_b16 v[26:27], v193 offset:32064
    ds_read_b64_tr_b16 v[28:29], v193 offset:30816
    ds_read_b64_tr_b16 v[30:31], v193 offset:32096
    ds_read_b64_tr_b16 v[32:33], v193 offset:30848
    ds_read_b64_tr_b16 v[34:35], v193 offset:32128
    s_waitcnt lgkmcnt(10)
    s_waitcnt vmcnt(9)
    v_mfma_f32_16x16x32_bf16 v[112:115], v[132:135], v[72:75], v[112:115]
    v_mfma_f32_16x16x32_bf16 v[116:119], v[136:139], v[72:75], v[116:119]
    v_mfma_f32_16x16x32_bf16 v[120:123], v[140:143], v[72:75], v[120:123]
    v_mfma_f32_16x16x32_bf16 v[124:127], v[144:147], v[72:75], v[124:127]
    v_mfma_f32_16x16x32_bf16 v[128:131], v[148:151], v[72:75], v[128:131]
    ds_read_b64_tr_b16 v[132:133], v193 offset:40960
    ds_read_b64_tr_b16 v[134:135], v193 offset:42240
    ds_read_b64_tr_b16 v[136:137], v193 offset:40992
    ds_read_b64_tr_b16 v[138:139], v193 offset:42272
    ds_read_b64_tr_b16 v[140:141], v193 offset:41024
    ds_read_b64_tr_b16 v[142:143], v193 offset:42304
    ds_read_b64_tr_b16 v[144:145], v193 offset:41056
    ds_read_b64_tr_b16 v[146:147], v193 offset:42336
    ds_read_b64_tr_b16 v[148:149], v193 offset:41088
    ds_read_b64_tr_b16 v[150:151], v193 offset:42368
    s_waitcnt lgkmcnt(10)
    s_waitcnt vmcnt(8)
    v_mfma_f32_16x16x32_bf16 v[112:115], v[16:19], v[76:79], v[112:115]
    v_mfma_f32_16x16x32_bf16 v[116:119], v[20:23], v[76:79], v[116:119]
    v_mfma_f32_16x16x32_bf16 v[120:123], v[24:27], v[76:79], v[120:123]
    v_mfma_f32_16x16x32_bf16 v[124:127], v[28:31], v[76:79], v[124:127]
    v_mfma_f32_16x16x32_bf16 v[128:131], v[32:35], v[76:79], v[128:131]
    ds_read_b64_tr_b16 v[16:17], v193 offset:51200
    ds_read_b64_tr_b16 v[18:19], v193 offset:52480
    ds_read_b64_tr_b16 v[20:21], v193 offset:51232
    ds_read_b64_tr_b16 v[22:23], v193 offset:52512
    ds_read_b64_tr_b16 v[24:25], v193 offset:51264
    ds_read_b64_tr_b16 v[26:27], v193 offset:52544
    ds_read_b64_tr_b16 v[28:29], v193 offset:51296
    ds_read_b64_tr_b16 v[30:31], v193 offset:52576
    ds_read_b64_tr_b16 v[32:33], v193 offset:51328
    ds_read_b64_tr_b16 v[34:35], v193 offset:52608
    s_waitcnt lgkmcnt(10)
    s_waitcnt vmcnt(7)
    v_mfma_f32_16x16x32_bf16 v[112:115], v[132:135], v[80:83], v[112:115]
    v_mfma_f32_16x16x32_bf16 v[116:119], v[136:139], v[80:83], v[116:119]
    v_mfma_f32_16x16x32_bf16 v[120:123], v[140:143], v[80:83], v[120:123]
    v_mfma_f32_16x16x32_bf16 v[124:127], v[144:147], v[80:83], v[124:127]
    v_mfma_f32_16x16x32_bf16 v[128:131], v[148:151], v[80:83], v[128:131]
    ds_read_b64_tr_b16 v[132:133], v193 offset:61440
    ds_read_b64_tr_b16 v[134:135], v193 offset:62720
    ds_read_b64_tr_b16 v[136:137], v193 offset:61472
    ds_read_b64_tr_b16 v[138:139], v193 offset:62752
    ds_read_b64_tr_b16 v[140:141], v193 offset:61504
    ds_read_b64_tr_b16 v[142:143], v193 offset:62784
    ds_read_b64_tr_b16 v[144:145], v193 offset:61536
    ds_read_b64_tr_b16 v[146:147], v193 offset:62816
    ds_read_b64_tr_b16 v[148:149], v193 offset:61568
    ds_read_b64_tr_b16 v[150:151], v193 offset:62848
    s_waitcnt lgkmcnt(10)
    s_waitcnt vmcnt(6)
    v_mfma_f32_16x16x32_bf16 v[112:115], v[16:19], v[84:87], v[112:115]
    v_mfma_f32_16x16x32_bf16 v[116:119], v[20:23], v[84:87], v[116:119]
    v_mfma_f32_16x16x32_bf16 v[120:123], v[24:27], v[84:87], v[120:123]
    v_mfma_f32_16x16x32_bf16 v[124:127], v[28:31], v[84:87], v[124:127]
    v_mfma_f32_16x16x32_bf16 v[128:131], v[32:35], v[84:87], v[128:131]
    ds_read_b64_tr_b16 v[16:17], v194 offset:10240
    ds_read_b64_tr_b16 v[18:19], v194 offset:11520
    ds_read_b64_tr_b16 v[20:21], v194 offset:10272
    ds_read_b64_tr_b16 v[22:23], v194 offset:11552
    ds_read_b64_tr_b16 v[24:25], v194 offset:10304
    ds_read_b64_tr_b16 v[26:27], v194 offset:11584
    ds_read_b64_tr_b16 v[28:29], v194 offset:10336
    ds_read_b64_tr_b16 v[30:31], v194 offset:11616
    ds_read_b64_tr_b16 v[32:33], v194 offset:10368
    ds_read_b64_tr_b16 v[34:35], v194 offset:11648
    s_waitcnt lgkmcnt(10)
    s_waitcnt vmcnt(5)
    v_mfma_f32_16x16x32_bf16 v[112:115], v[132:135], v[88:91], v[112:115]
    v_mfma_f32_16x16x32_bf16 v[116:119], v[136:139], v[88:91], v[116:119]
    v_mfma_f32_16x16x32_bf16 v[120:123], v[140:143], v[88:91], v[120:123]
    v_mfma_f32_16x16x32_bf16 v[124:127], v[144:147], v[88:91], v[124:127]
    v_mfma_f32_16x16x32_bf16 v[128:131], v[148:151], v[88:91], v[128:131]
    s_waitcnt lgkmcnt(0)
    s_waitcnt vmcnt(4)
    v_mfma_f32_16x16x32_bf16 v[112:115], v[16:19], v[92:95], v[112:115]
    v_mfma_f32_16x16x32_bf16 v[116:119], v[20:23], v[92:95], v[116:119]
    v_mfma_f32_16x16x32_bf16 v[120:123], v[24:27], v[92:95], v[120:123]
    v_mfma_f32_16x16x32_bf16 v[124:127], v[28:31], v[92:95], v[124:127]
    v_mfma_f32_16x16x32_bf16 v[128:131], v[32:35], v[92:95], v[128:131]
    s_waitcnt vmcnt(0)
    s_barrier
    ds_read_b64_tr_b16 v[132:133], v194 offset:20480
    ds_read_b64_tr_b16 v[134:135], v194 offset:21760
    ds_read_b64_tr_b16 v[136:137], v194 offset:20512
    ds_read_b64_tr_b16 v[138:139], v194 offset:21792
    ds_read_b64_tr_b16 v[140:141], v194 offset:20544
    ds_read_b64_tr_b16 v[142:143], v194 offset:21824
    ds_read_b64_tr_b16 v[144:145], v194 offset:20576
    ds_read_b64_tr_b16 v[146:147], v194 offset:21856
    ds_read_b64_tr_b16 v[148:149], v194 offset:20608
    ds_read_b64_tr_b16 v[150:151], v194 offset:21888
    ds_read_b64_tr_b16 v[16:17], v194 offset:30720
    ds_read_b64_tr_b16 v[18:19], v194 offset:32000
    ds_read_b64_tr_b16 v[20:21], v194 offset:30752
    ds_read_b64_tr_b16 v[22:23], v194 offset:32032
    ds_read_b64_tr_b16 v[24:25], v194 offset:30784
    ds_read_b64_tr_b16 v[26:27], v194 offset:32064
    ds_read_b64_tr_b16 v[28:29], v194 offset:30816
    ds_read_b64_tr_b16 v[30:31], v194 offset:32096
    ds_read_b64_tr_b16 v[32:33], v194 offset:30848
    ds_read_b64_tr_b16 v[34:35], v194 offset:32128
    s_waitcnt lgkmcnt(10)
    v_mfma_f32_16x16x32_bf16 v[112:115], v[132:135], v[96:99], v[112:115]
    v_mfma_f32_16x16x32_bf16 v[116:119], v[136:139], v[96:99], v[116:119]
    v_mfma_f32_16x16x32_bf16 v[120:123], v[140:143], v[96:99], v[120:123]
    v_mfma_f32_16x16x32_bf16 v[124:127], v[144:147], v[96:99], v[124:127]
    v_mfma_f32_16x16x32_bf16 v[128:131], v[148:151], v[96:99], v[128:131]
    s_waitcnt lgkmcnt(0)
    v_mfma_f32_16x16x32_bf16 v[112:115], v[16:19], v[100:103], v[112:115]
    v_mfma_f32_16x16x32_bf16 v[116:119], v[20:23], v[100:103], v[116:119]
    v_mfma_f32_16x16x32_bf16 v[120:123], v[24:27], v[100:103], v[120:123]
    v_mfma_f32_16x16x32_bf16 v[124:127], v[28:31], v[100:103], v[124:127]
    v_mfma_f32_16x16x32_bf16 v[128:131], v[32:35], v[100:103], v[128:131]
    s_nop 7
    s_mul_i32 s61, s58, 5120
    s_add_u32 s61, s61, 133120
    v_add_u32 v56, s61, v177
    s_cmp_eq_u32 s59, 0
    s_cbranch_scc1 L_red
    ds_write_b128 v56, v[112:115] offset:0
    ds_write_b128 v56, v[116:119] offset:1024
    ds_write_b128 v56, v[120:123] offset:2048
    ds_write_b128 v56, v[124:127] offset:3072
    ds_write_b128 v56, v[128:131] offset:4096
    s_waitcnt lgkmcnt(0)
    s_barrier
    s_endpgm
L_red:
    s_barrier
    ds_read_b128 v[32:35], v56 offset:0
    ds_read_b128 v[36:39], v56 offset:1024
    ds_read_b128 v[40:43], v56 offset:2048
    ds_read_b128 v[44:47], v56 offset:3072
    ds_read_b128 v[48:51], v56 offset:4096
    s_waitcnt lgkmcnt(0)
    v_add_f32 v112, v112, v32
    v_add_f32 v113, v113, v33
    v_add_f32 v114, v114, v34
    v_add_f32 v115, v115, v35
    v_add_f32 v116, v116, v36
    v_add_f32 v117, v117, v37
    v_add_f32 v118, v118, v38
    v_add_f32 v119, v119, v39
    v_add_f32 v120, v120, v40
    v_add_f32 v121, v121, v41
    v_add_f32 v122, v122, v42
    v_add_f32 v123, v123, v43
    v_add_f32 v124, v124, v44
    v_add_f32 v125, v125, v45
    v_add_f32 v126, v126, v46
    v_add_f32 v127, v127, v47
    v_add_f32 v128, v128, v48
    v_add_f32 v129, v129, v49
    v_add_f32 v130, v130, v50
    v_add_f32 v131, v131, v51
    v_and_b32 v57, 15, v1
    v_mul_u32_u24 v57, 1280, v57
    v_lshrrev_b32 v2, 4, v1
    v_lshl_add_u32 v57, v2, 3, v57
    s_lshl_b32 s61, s44, 6
    s_lshl_b32 s62, s58, 4
    s_add_u32 s61, s61, s62
    s_mul_i32 s61, s61, 1280
    s_add_u32 s61, s61, s72
    v_cvt_pk_bf16_f32 v64, v112, v113
    v_cvt_pk_bf16_f32 v65, v114, v115
    buffer_store_dwordx2 v[64:65], v57, s[12:15], s61 offen offset:0
    v_cvt_pk_bf16_f32 v66, v116, v117
    v_cvt_pk_bf16_f32 v67, v118, v119
    buffer_store_dwordx2 v[66:67], v57, s[12:15], s61 offen offset:32
    v_cvt_pk_bf16_f32 v68, v120, v121
    v_cvt_pk_bf16_f32 v69, v122, v123
    buffer_store_dwordx2 v[68:69], v57, s[12:15], s61 offen offset:64
    v_cvt_pk_bf16_f32 v70, v124, v125
    v_cvt_pk_bf16_f32 v71, v126, v127
    buffer_store_dwordx2 v[70:71], v57, s[12:15], s61 offen offset:96
    v_cvt_pk_bf16_f32 v72, v128, v129
    v_cvt_pk_bf16_f32 v73, v130, v131
    buffer_store_dwordx2 v[72:73], v57, s[12:15], s61 offen offset:128
    s_endpgm
L_rare_k_1:
    s_memrealtime s[62:63]
    s_waitcnt lgkmcnt(0)
    s_or_b32 s62, s62, 1
    v_mov_b32 v16, s62
    v_mov_b32 v17, 0
    s_mov_b64 exec, 1
    buffer_store_dword v16, v17, s[28:31], 0 offen sc1
    s_mov_b64 exec, -1
    s_branch L_back_k_2
L_rare_k_6:
    s_cmp_eq_u32 s35, 1
    s_cbranch_scc0 L_gw_k_5
    s_waitcnt vmcnt(9)
    s_branch L_gw_k_3
L_gw_k_5:
    s_waitcnt vmcnt(7)
    s_branch L_gw_k_3
    s_branch L_back_k_7
L_rare_k_11:
    s_cmp_eq_u32 s35, 1
    s_cbranch_scc0 L_gw_k_10
    s_waitcnt vmcnt(9)
    s_branch L_gw_k_8
L_gw_k_10:
    s_waitcnt vmcnt(7)
    s_branch L_gw_k_8
    s_branch L_back_k_12
L_rare_k_16:
    s_cmp_eq_u32 s35, 1
    s_cbranch_scc0 L_gw_k_15
    s_waitcnt vmcnt(9)
    s_branch L_gw_k_13
L_gw_k_15:
    s_waitcnt vmcnt(7)
    s_branch L_gw_k_13
    s_branch L_back_k_17
L_rare_k_18:
    v_mov_b32 v3, 0
    v_readfirstlane_b32 s60, v62
    s_nop 3
    s_cmp_lg_u32 s60, 0
    s_cbranch_scc1 L_nk_k_49
    s_mov_b32 s75, 0
L_spn_k_50:
    buffer_load_dword v62, v3, s[28:31], 0 offen sc1
    s_waitcnt vmcnt(0)
    v_readfirstlane_b32 s60, v62
    s_nop 3
    s_cmp_lg_u32 s60, 0
    s_cbranch_scc1 L_spdn_k_51
    s_add_u32 s75, s75, 1
    s_cmp_ge_u32 s75, 131072
    s_cbranch_scc1 L_spdn_k_51
    s_sleep 2
    s_branch L_spn_k_50
L_spdn_k_51:
L_nk_k_49:
    s_lshl_b32 s61, s56, 4
    s_add_u32 s61, s61, s57
    s_lshl_b32 s61, s61, 2
    s_add_u32 s61, s61, 16785408
    v_mov_b32 v2, s60
    s_mov_b64 exec, 1
    buffer_store_dword v2, v3, s[24:27], s61 offen sc1
    s_mov_b64 exec, -1
    s_branch L_back_k_19
L_rare_k_20:
    s_mov_b32 s62, 16785408
    buffer_load_dwordx4 v[56:59], v177, s[24:27], s62 offen sc1
    s_branch L_back_k_21
L_rare_k_22:
    v_cmp_ne_u32 vcc, s60, v56
    v_cmp_ne_u32 s[62:63], s60, v57
    s_or_b64 vcc, vcc, s[62:63]
    v_cmp_ne_u32 s[62:63], s60, v58
    s_or_b64 vcc, vcc, s[62:63]
    v_cmp_ne_u32 s[62:63], s60, v59
    s_or_b64 vcc, vcc, s[62:63]
    s_cmp_eq_u64 vcc, 0
    s_cbranch_scc1 L_ppf1_k_52
    s_mov_b32 s75, 0
L_spf1_k_53:
    s_mov_b32 s62, 16785408
    buffer_load_dwordx4 v[56:59], v177, s[24:27], s62 offen sc1
    s_waitcnt vmcnt(0)
    v_cmp_ne_u32 vcc, s60, v56
    v_cmp_ne_u32 s[62:63], s60, v57
    s_or_b64 vcc, vcc, s[62:63]
    v_cmp_ne_u32 s[62:63], s60, v58
    s_or_b64 vcc, vcc, s[62:63]
    v_cmp_ne_u32 s[62:63], s60, v59
    s_or_b64 vcc, vcc, s[62:63]
    s_cmp_eq_u64 vcc, 0
    s_cbranch_scc1 L_spdf1_k_54
    s_add_u32 s75, s75, 1
    s_cmp_ge_u32 s75, 131072
    s_cbranch_scc1 L_spdf1_k_54
    s_sleep 2
    s_branch L_spf1_k_53
L_spdf1_k_54:
L_ppf1_k_52:
    s_branch L_back_k_23
L_rare_k_27:
    buffer_load_dwordx4 v[200:203], v183, s[24:27], s71 offen sc1
    s_add_u32 s71, s71, 4096
    buffer_load_dwordx4 v[204:207], v183, s[24:27], s71 offen sc1
    s_add_u32 s71, s71, 4096
    buffer_load_dwordx4 v[208:211], v183, s[24:27], s71 offen sc1
    s_add_u32 s71, s71, 4096
    s_branch L_back_k_28
L_rare_k_29:
    v_mov_b32 v185, v188
    s_mov_b32 s16, s8
    s_mov_b32 s17, s9
    s_mov_b32 s18, s10
    s_mov_b32 s19, s11
    s_mul_i32 s67, s73, 51200
    s_add_u32 s67, s67, s72
    s_mov_b32 s74, 102400
    s_branch L_back_k_30
L_rare_k_31:
    s_cmp_eq_u32 s3, 0
    s_cbranch_scc0 L_back_k_32
    v_cmp_ne_u32 vcc, s60, v57
    s_nop 0
    s_cmp_eq_u64 vcc, 0
    s_cbranch_scc1 L_ppf2_k_55
    s_mov_b32 s75, 0
L_spf2_k_56:
    s_lshr_b32 s62, s44, 1
    s_lshl_b32 s62, s62, 6
    s_add_u32 s62, s62, 16786432
    v_and_b32 v56, 15, v1
    v_lshlrev_b32 v56, 2, v56
    buffer_load_dword v57, v56, s[24:27], s62 offen sc1
    s_waitcnt vmcnt(0)
    v_cmp_ne_u32 vcc, s60, v57
    s_nop 0
    s_cmp_eq_u64 vcc, 0
    s_cbranch_scc1 L_spdf2_k_57
    s_add_u32 s75, s75, 1
    s_cmp_ge_u32 s75, 131072
    s_cbranch_scc1 L_spdf2_k_57
    s_sleep 2
    s_branch L_spf2_k_56
L_spdf2_k_57:
L_ppf2_k_55:
    s_branch L_back_k_32
L_rare_k_33:
    buffer_load_dwordx4 v[200:203], v183, s[24:27], s71 offen sc1
    s_add_u32 s71, s71, 4096
    buffer_load_dwordx4 v[204:207], v183, s[24:27], s71 offen sc1
    s_add_u32 s71, s71, 4096
    buffer_load_dwordx4 v[208:211], v183, s[24:27], s71 offen sc1
    s_add_u32 s71, s71, 4096
    s_branch L_back_k_34
L_rare_k_35:
    s_cmp_eq_u32 s3, 0
    s_cbranch_scc0 L_back_k_36
    s_lshr_b32 s62, s44, 1
    s_lshl_b32 s62, s62, 6
    s_add_u32 s62, s62, 16786432
    v_and_b32 v56, 15, v1
    v_lshlrev_b32 v56, 2, v56
    buffer_load_dword v57, v56, s[24:27], s62 offen sc1
    s_branch L_back_k_36
L_rare_k_37:
    s_cmp_eq_u32 s3, 0
    s_cbranch_scc0 L_back_k_38
    s_lshl_b32 s61, s56, 4
    s_add_u32 s61, s61, s57
    s_lshl_b32 s61, s61, 2
    s_add_u32 s61, s61, 16786432
    v_mov_b32 v2, s60
    v_mov_b32 v3, 0
    s_mov_b64 exec, 1
    buffer_store_dword v2, v3, s[24:27], s61 offen sc1
    s_mov_b64 exec, -1
    s_branch L_back_k_38
L_rare_k_39:
    v_mov_b32 v185, v188
    s_mov_b32 s16, s8
    s_mov_b32 s17, s9
    s_mov_b32 s18, s10
    s_mov_b32 s19, s11
    s_mul_i32 s67, s73, 51200
    s_add_u32 s67, s67, s72
    s_mov_b32 s74, 102400
    v_mov_b32 v186, v189
    s_mov_b32 s20, s8
    s_mov_b32 s21, s9
    s_mov_b32 s22, s10
    s_mov_b32 s23, s11
    s_add_u32 s69, s72, 51200
    s_mov_b32 s70, 102400
    s_branch L_back_k_40
L_fallback:
    s_mov_b64 s[100:101], 0
    s_cmp_eq_u32 s59, 0
    s_cbranch_scc0 L_fq_k_58
    v_mov_b32 v56, v160
    v_mov_b32 v60, v164
    v_mov_b32 v57, v161
    v_mov_b32 v61, v165
    v_mov_b32 v58, v162
    v_mov_b32 v62, v166
    v_mov_b32 v59, v163
    v_mov_b32 v63, v167
    s_branch L_fq_k_59
L_fq_k_58:
    v_mov_b32 v56, v168
    v_mov_b32 v60, v172
    v_mov_b32 v57, v169
    v_mov_b32 v61, v173
    v_mov_b32 v58, v170
    v_mov_b32 v62, v174
    v_mov_b32 v59, v171
    v_mov_b32 v63, v175
L_fq_k_59:
    v_lshrrev_b32 v98, 5, v1
    v_mul_u32_u24 v98, 320, v98
    v_and_b32 v99, 31, v1
    v_lshl_add_u32 v96, v99, 4, v98
    v_mov_b32 v97, 0xff800000
    s_mul_i32 s61, s48, 163840
    s_mov_b32 s62, 0
L_fb1:
    buffer_load_dwordx4 v[16:19], v177, s[40:43], s61 offen sc1
    buffer_load_dwordx2 v[20:21], v178, s[40:43], s61 offen offset:1024 sc1
    s_waitcnt vmcnt(0)
    v_mfma_f32_32x32x16_bf16 v[64:79], v[16:19], v[56:59], 0
    v_mfma_f32_32x32x16_bf16 v[64:79], v[20:23], v[60:63], v[64:79]
    s_nop 7
    s_nop 7
    v_max3_f32 v97, v97, v64, v65
    v_max3_f32 v97, v97, v66, v67
    v_max3_f32 v97, v97, v68, v69
    v_max3_f32 v97, v97, v70, v71
    v_max3_f32 v97, v97, v72, v73
    v_max3_f32 v97, v97, v74, v75
    v_max3_f32 v97, v97, v76, v77
    v_max3_f32 v97, v97, v78, v79
    s_add_u32 s61, s61, 2560
    s_add_u32 s62, s62, 1
    s_cmp_lt_u32 s62, 64
    s_cbranch_scc1 L_fb1
    v_mov_b32 v98, v97
    v_mov_b32 v99, v97
    s_nop 1
    v_permlane32_swap_b32 v98, v99
    s_nop 1
    v_max3_f32 v98, v98, v99, v97
    v_sub_f32 v98, 0, v98
    v_and_b32 v99, 0xffff0000, v98
    v_sub_f32 v98, v98, v99
    v_and_b32 v100, 0xffff0000, v98
    v_sub_f32 v98, v98, v100
    v_lshrrev_b32 v99, 16, v99
    v_or_b32 v99, v99, v100
    v_cvt_pk_bf16_f32 v100, v98, 0
    v_cmp_gt_u32 vcc, 32, v1
    s_nop 1
    v_cndmask_b32 v62, 0, v99, vcc
    v_cndmask_b32 v63, 0, v100, vcc
    v_mov_b32 v232, 0
    v_mov_b32 v233, 0
    v_mov_b32 v234, 0
    v_mov_b32 v235, 0
    v_mov_b32 v236, 0
    v_mov_b32 v237, 0
    v_mov_b32 v238, 0
    v_mov_b32 v239, 0
    v_mov_b32 v240, 0
    v_mov_b32 v241, 0
    v_mov_b32 v242, 0
    v_mov_b32 v243, 0
    v_mov_b32 v244, 0
    v_mov_b32 v245, 0
    v_mov_b32 v246, 0
    v_mov_b32 v247, 0
    s_mul_i32 s61, s48, 163840
    s_mov_b32 s62, 0
L_fb2:
    buffer_load_dwordx4 v[16:19], v177, s[40:43], s61 offen sc1
    buffer_load_dwordx2 v[20:21], v178, s[40:43], s61 offen offset:1024 sc1
    s_mov_b64 exec, s[0:1]
    buffer_load_dwordx4 v[24:27], v96, s[40:43], s61 offen offset:1280 sc1
    buffer_load_dwordx4 v[28:31], v96, s[40:43], s61 offen offset:1920 sc1
    s_mov_b64 exec, -1
    s_waitcnt vmcnt(0)
    v_mfma_f32_32x32x16_bf16 v[64:79], v[16:19], v[56:59], 0
    v_mfma_f32_32x32x16_bf16 v[64:79], v[20:23], v[60:63], v[64:79]
    s_nop 7
    s_nop 7
    v_exp_f32 v100, v64
    v_exp_f32 v101, v65
    v_exp_f32 v102, v66
    v_exp_f32 v103, v67
    v_exp_f32 v104, v68
    v_exp_f32 v105, v69
    v_exp_f32 v106, v70
    v_exp_f32 v107, v71
    v_exp_f32 v108, v72
    v_exp_f32 v109, v73
    v_exp_f32 v110, v74
    v_exp_f32 v111, v75
    v_exp_f32 v80, v76
    v_exp_f32 v81, v77
    v_exp_f32 v82, v78
    v_exp_f32 v83, v79
    s_nop 0
    v_cvt_pk_bf16_f32 v48, v100, v101
    v_cvt_pk_bf16_f32 v49, v102, v103
    v_cvt_pk_bf16_f32 v50, v104, v105
    v_cvt_pk_bf16_f32 v51, v106, v107
    v_cvt_pk_bf16_f32 v52, v108, v109
    v_cvt_pk_bf16_f32 v53, v110, v111
    v_cvt_pk_bf16_f32 v54, v80, v81
    v_cvt_pk_bf16_f32 v55, v82, v83
    s_nop 1
    v_mfma_f32_32x32x16_bf16 v[232:247], v[24:27], v[48:51], v[232:247]
    v_mfma_f32_32x32x16_bf16 v[232:247], v[28:31], v[52:55], v[232:247]
    s_add_u32 s61, s61, 2560
    s_add_u32 s62, s62, 1
    s_cmp_lt_u32 s62, 64
    s_cbranch_scc1 L_fb2
    s_nop 7
    s_nop 7
    v_mov_b32 v216, v232
    v_mov_b32 v217, v233
    v_mov_b32 v218, v234
    v_mov_b32 v219, v235
    v_mov_b32 v220, v236
    v_mov_b32 v221, v237
    v_mov_b32 v222, v238
    v_mov_b32 v223, v239
    v_mov_b32 v224, v240
    v_mov_b32 v225, v241
    v_mov_b32 v226, v242
    v_mov_b32 v227, v243
    s_branch L_norm
.section .rodata,"a"
.p2align 6
.amdhsa_kernel gated_mix__mha_block__glu_gated_geglu__prompt_kernel
  .amdhsa_next_free_vgpr 256
  .amdhsa_next_free_sgpr 102
  .amdhsa_accum_offset 256
  .amdhsa_group_segment_fixed_size 0
  .amdhsa_kernarg_size 88
  .amdhsa_user_sgpr_count 2
  .amdhsa_user_sgpr_kernarg_segment_ptr 1
  .amdhsa_system_sgpr_workgroup_id_x 1
  .amdhsa_float_denorm_mode_32 3
.end_amdhsa_kernel
```
